```python
import torch

def _softmax(x, axis=-1):
    return torch.softmax(x, dim=axis)
def _gelu(x):
    return torch.nn.functional.gelu(x, approximate="tanh")
def _silu(x):
    return torch.nn.functional.silu(x)
def _sigmoid(x):
    return torch.sigmoid(x)
def _layernorm(x, axis=-1, eps=1e-5):
    m = x.mean(dim=axis, keepdim=True)
    v = x.var(dim=axis, keepdim=True, unbiased=False)
    return (x - m) / torch.sqrt(v + eps)
def _scatter_add(tgt, idx, src, axis=0):
    return tgt.clone().index_add_(axis, idx, src)
def _segment_sum(src, seg, n):
    out = torch.zeros((n,) + src.shape[1:], dtype=src.dtype)
    return out.index_add_(0, seg, src)
def _pad(x, pw):
    flat = tuple(v for pair in reversed(pw) for v in pair)
    return torch.nn.functional.pad(x, flat)

kernel_name = 'recurrent_scan__mha_block_cached__geglu_ffn__decode'

def setup_inputs():

    _w = (lambda a: (lambda t: t.to(torch.bfloat16) if t.is_floating_point() else t)(torch.as_tensor(a)))
    def _A_setup():
        B, Sq, D = 4, 1, 640
        H, Sk, Dh = 32, 4096, 192
        return {
            "x": _w((lambda *s: torch.randn(*s, dtype=torch.bfloat16) * 0.05)(B, Sq, D)),
            "k_cache": _w((lambda *s: torch.randn(*s, dtype=torch.bfloat16) * 1.6)(B, H, Sk, Dh)),
            "v_cache": _w((lambda *s: torch.randn(*s, dtype=torch.bfloat16) * 0.2)(B, H, Sk, Dh)),
            "wq": _w((lambda *s: torch.randn(*s, dtype=torch.bfloat16) * 1.6)(D, H * Dh) * (D ** -0.5)),
            "wo": _w((lambda *s: torch.randn(*s, dtype=torch.bfloat16) * 0.2)(H * Dh, D) * ((H * Dh) ** -0.5)),
        }
    _A_in = _A_setup()

    def _B_setup():
        B, S, D, F = 4, 1, 640, 1536
        return {
            "x": _w((lambda *s: torch.randn(*s, dtype=torch.bfloat16) * 0.05)(B, S, D)),
            "w_gate": _w((lambda *s: torch.randn(*s, dtype=torch.bfloat16) * 0.1)(D, F)),
            "w_up": _w((lambda *s: torch.randn(*s, dtype=torch.bfloat16) * 0.1)(D, F)),
            "w_down": _w((lambda *s: torch.randn(*s, dtype=torch.bfloat16) * 0.1)(F, D)),
        }
    _B_in = _B_setup()

    return {
        "A_x": _A_in["x"],
        "A_k_cache": _A_in["k_cache"],
        "A_v_cache": _A_in["v_cache"],
        "A_wq": _A_in["wq"],
        "A_wo": _A_in["wo"],
        "B_x": _B_in["x"],
        "B_w_gate": _B_in["w_gate"],
        "B_w_up": _B_in["w_up"],
        "B_w_down": _B_in["w_down"],
    }

def reference(A_x, A_k_cache, A_v_cache, A_wq, A_wo, B_x, B_w_gate, B_w_up, B_w_down):
    def _A_ref(x, k_cache, v_cache, wq, wo):
        B, Sq, D = x.shape
        H, Dh = 32, 192
        q = (lambda x, *d: x.permute(*d))((x @ wq).reshape(B, Sq, H, Dh), 0, 2, 1, 3)
        scores = torch.einsum("bhqd,bhkd->bhqk", q, k_cache) * (Dh ** -0.5)
        p = _softmax(scores, axis=-1)
        o = torch.einsum("bhqk,bhkd->bhqd", p, v_cache)
        return (lambda x, *d: x.permute(*d))(o, 0, 2, 1, 3).reshape(B, Sq, H * Dh) @ wo

    def _B_ref(x, w_gate, w_up, w_down):
        return (_gelu(x @ w_gate) * (x @ w_up)) @ w_down

    x = A_x
    xn = _layernorm(x, axis=-1)
    s = _A_ref(xn, A_k_cache, A_v_cache, A_wq, A_wo)
    g = _silu(_B_ref(xn, B_w_gate, B_w_up, B_w_down))
    return x + s * g
```

```asm
; @launch grid=(256,1,1) block=(512,1,1) lds=118784
.amdgcn_target "amdgcn-amd-amdhsa--gfx950"
.text
  .globl recurrent_scan__mha_block_cached__geglu_ffn__decode_kernel
  .p2align 8
  .type recurrent_scan__mha_block_cached__geglu_ffn__decode_kernel,@function
  recurrent_scan__mha_block_cached__geglu_ffn__decode_kernel:
  s_cmp_ge_u32 s2, 256
  s_cbranch_scc1 L_end
  s_load_dwordx16 s[4:19], s[0:1], 0
  s_load_dwordx8 s[20:27], s[0:1], 64
  v_and_b32 v1, 63, v0
  v_lshrrev_b32 v2, 6, v0
  s_nop 0
  v_readfirstlane_b32 s31, v2
  s_lshr_b32 s28, s2, 3
  s_and_b32 s29, s2, 7
  s_add_u32 s30, s28, s29
  s_and_b32 s30, s30, 7
  s_lshr_b32 s40, s29, 1
  s_xor_b32 s40, s40, s29
  s_and_b32 s40, s40, 1
  s_lshr_b32 s41, s29, 2
  s_lshl_b32 s41, s41, 1
  s_add_u32 s55, s40, s41
  s_and_b32 s59, s29, 1
  s_add_u32 s40, s55, s28
  s_and_b32 s40, s40, 3
  s_lshl_b32 s40, s40, 1
  s_lshr_b32 s41, s28, 2
  s_add_u32 s41, s41, s59
  s_and_b32 s41, s41, 1
  s_add_u32 s30, s40, s41
  s_waitcnt lgkmcnt(0)
  s_cmp_ge_u32 s31, 4
  s_cbranch_scc1 L_stream
  s_setprio 2
  s_load_dword s60, s[26:27], 0
  s_mov_b32 s58, 0
  v_mov_b32 v2, 5376
  v_mov_b32 v4, 0
  v_mov_b32 v5, 0
  v_mov_b32 v6, 0
  v_mov_b32 v7, 0
  ds_write_b128 v2, v[4:7]
  ds_write_b128 v2, v[4:7] offset:16
  s_cmp_ge_u32 s30, 6
  s_cbranch_scc1 A_n
A_q:
  s_mov_b32 s32, s4
  s_mov_b32 s33, s5
  s_mov_b32 s34, 5120
  s_mov_b32 s35, 0x20000
  s_mul_i32 s40, s31, 1280
  v_lshl_add_u32 v3, v1, 2, s40
  buffer_load_dword v10, v3, s[32:35], 0 offen offset:0
  buffer_load_dword v11, v3, s[32:35], 0 offen offset:256
  buffer_load_dword v12, v3, s[32:35], 0 offen offset:512
  buffer_load_dword v13, v3, s[32:35], 0 offen offset:768
  buffer_load_dword v14, v3, s[32:35], 0 offen offset:1024
  s_cmp_lg_u32 s30, 0
  s_cbranch_scc1 L_cz_1
  s_cmp_lg_u32 s31, 0
  s_cbranch_scc1 L_cz_1
  s_lshl_b32 s40, s28, 10
  s_add_u32 s40, s40, 4096
  v_lshl_add_u32 v2, v1, 8, s40
  v_mov_b32 v4, 0
  s_mov_b64 exec, 0xf
  global_store_dword v2, v4, s[26:27] sc1
  s_mov_b64 exec, -1
L_cz_1:
  s_mov_b32 s36, s10
  s_mov_b32 s37, s11
  s_mov_b32 s38, 7864320
  s_mov_b32 s39, 0x20000
  s_cmp_ge_u32 s30, 3
  s_cselect_b32 s41, 1, 0
  s_mul_i32 s42, s41, 3
  s_sub_u32 s43, s30, s42
  s_mul_i32 s42, s41, 320
  s_mul_i32 s44, s42, 12288
  s_mul_i32 s45, s28, 384
  s_add_u32 s44, s44, s45
  s_lshl_b32 s45, s43, 7
  s_add_u32 s44, s44, s45
  s_mul_i32 s45, s31, 98304
  s_add_u32 s44, s44, s45
  s_lshl_b32 s45, s31, 10
  s_add_u32 s45, s45, 20480
  v_lshrrev_b32 v2, 3, v1
  v_and_b32 v3, 6, v2
  v_and_b32 v40, 7, v1
  v_xor_b32 v40, v40, v3
  v_lshlrev_b32 v40, 4, v40
  s_mov_b32 s40, 12288
  v_mad_u32_u24 v40, v2, s40, v40
  s_mov_b32 m0, s45
  s_nop 0
  buffer_load_dwordx4 v40, s[36:39], s44 offen nt lds
  s_add_u32 s44, s44, 393216
  s_add_u32 s45, s45, 4096
  s_mov_b32 m0, s45
  s_nop 0
  buffer_load_dwordx4 v40, s[36:39], s44 offen nt lds
  s_add_u32 s44, s44, 393216
  s_add_u32 s45, s45, 4096
  s_mov_b32 m0, s45
  s_nop 0
  buffer_load_dwordx4 v40, s[36:39], s44 offen nt lds
  s_add_u32 s44, s44, 393216
  s_add_u32 s45, s45, 4096
  s_mov_b32 m0, s45
  s_nop 0
  buffer_load_dwordx4 v40, s[36:39], s44 offen nt lds
  s_add_u32 s44, s44, 393216
  s_add_u32 s45, s45, 4096
  s_mov_b32 m0, s45
  s_nop 0
  buffer_load_dwordx4 v40, s[36:39], s44 offen nt lds
  s_add_u32 s44, s44, 393216
  s_add_u32 s45, s45, 4096
  s_mov_b32 m0, s45
  s_nop 0
  buffer_load_dwordx4 v40, s[36:39], s44 offen nt lds
  s_add_u32 s44, s44, 393216
  s_add_u32 s45, s45, 4096
  s_mov_b32 m0, s45
  s_nop 0
  buffer_load_dwordx4 v40, s[36:39], s44 offen nt lds
  s_add_u32 s44, s44, 393216
  s_add_u32 s45, s45, 4096
  s_mov_b32 m0, s45
  s_nop 0
  buffer_load_dwordx4 v40, s[36:39], s44 offen nt lds
  s_add_u32 s44, s44, 393216
  s_add_u32 s45, s45, 4096
  s_mov_b32 m0, s45
  s_nop 0
  buffer_load_dwordx4 v40, s[36:39], s44 offen nt lds
  s_add_u32 s44, s44, 393216
  s_add_u32 s45, s45, 4096
  s_mov_b32 m0, s45
  s_nop 0
  buffer_load_dwordx4 v40, s[36:39], s44 offen nt lds
  s_waitcnt lgkmcnt(0)
  s_add_u32 s60, s60, 1
  s_not_b32 s61, s60
  s_mov_b32 s57, 0x3ff
  v_mov_b32 v159, s60
  s_waitcnt vmcnt(10)
  v_lshlrev_b32 v20, 16, v10
  v_and_b32 v21, 0xffff0000, v10
  v_lshlrev_b32 v22, 16, v11
  v_and_b32 v23, 0xffff0000, v11
  v_lshlrev_b32 v24, 16, v12
  v_and_b32 v25, 0xffff0000, v12
  v_lshlrev_b32 v26, 16, v13
  v_and_b32 v27, 0xffff0000, v13
  v_lshlrev_b32 v28, 16, v14
  v_and_b32 v29, 0xffff0000, v14
  v_add_f32 v30, v20, v21
  v_add_f32 v30, v30, v22
  v_add_f32 v30, v30, v23
  v_add_f32 v30, v30, v24
  v_add_f32 v30, v30, v25
  v_add_f32 v30, v30, v26
  v_add_f32 v30, v30, v27
  v_add_f32 v30, v30, v28
  v_add_f32 v30, v30, v29
  s_nop 1
  v_add_f32_dpp v30, v30, v30 quad_perm:[1,0,3,2] row_mask:0xf bank_mask:0xf
  s_nop 1
  v_add_f32_dpp v30, v30, v30 quad_perm:[2,3,0,1] row_mask:0xf bank_mask:0xf
  s_nop 1
  v_add_f32_dpp v30, v30, v30 row_half_mirror row_mask:0xf bank_mask:0xf
  s_nop 1
  v_add_f32_dpp v30, v30, v30 row_mirror row_mask:0xf bank_mask:0xf
  v_mov_b32 v31, v30
  s_nop 1
  v_permlane16_swap_b32 v30, v31
  v_add_f32 v30, v30, v31
  v_mov_b32 v31, v30
  s_nop 1
  v_permlane32_swap_b32 v30, v31
  v_add_f32 v30, v30, v31
  v_mul_f32 v30, 0x3acccccd, v30
  v_sub_f32 v32, v20, v30
  v_mul_f32 v33, v32, v32
  v_sub_f32 v32, v21, v30
  v_fmac_f32 v33, v32, v32
  v_sub_f32 v32, v22, v30
  v_fmac_f32 v33, v32, v32
  v_sub_f32 v32, v23, v30
  v_fmac_f32 v33, v32, v32
  v_sub_f32 v32, v24, v30
  v_fmac_f32 v33, v32, v32
  v_sub_f32 v32, v25, v30
  v_fmac_f32 v33, v32, v32
  v_sub_f32 v32, v26, v30
  v_fmac_f32 v33, v32, v32
  v_sub_f32 v32, v27, v30
  v_fmac_f32 v33, v32, v32
  v_sub_f32 v32, v28, v30
  v_fmac_f32 v33, v32, v32
  v_sub_f32 v32, v29, v30
  v_fmac_f32 v33, v32, v32
  s_nop 1
  v_add_f32_dpp v33, v33, v33 quad_perm:[1,0,3,2] row_mask:0xf bank_mask:0xf
  s_nop 1
  v_add_f32_dpp v33, v33, v33 quad_perm:[2,3,0,1] row_mask:0xf bank_mask:0xf
  s_nop 1
  v_add_f32_dpp v33, v33, v33 row_half_mirror row_mask:0xf bank_mask:0xf
  s_nop 1
  v_add_f32_dpp v33, v33, v33 row_mirror row_mask:0xf bank_mask:0xf
  v_mov_b32 v31, v33
  s_nop 1
  v_permlane16_swap_b32 v33, v31
  v_add_f32 v33, v33, v31
  v_mov_b32 v31, v33
  s_nop 1
  v_permlane32_swap_b32 v33, v31
  v_add_f32 v33, v33, v31
  v_mul_f32 v33, 0x3acccccd, v33
  v_cvt_pk_bf16_f32 v33, v33, v33
  v_and_b32 v33, 0xffff0000, v33
  v_add_f32 v33, 0x3727c5ac, v33
  v_cvt_pk_bf16_f32 v33, v33, v33
  v_and_b32 v33, 0xffff0000, v33
  v_sqrt_f32 v33, v33
  s_nop 0
  v_cvt_pk_bf16_f32 v33, v33, v33
  v_and_b32 v33, 0xffff0000, v33
  v_rcp_f32 v34, v33
  v_cvt_pk_bf16_f32 v30, v30, v30
  v_and_b32 v30, 0xffff0000, v30
  v_sub_f32 v20, v20, v30
  v_sub_f32 v21, v21, v30
  v_sub_f32 v22, v22, v30
  v_sub_f32 v23, v23, v30
  v_sub_f32 v24, v24, v30
  v_sub_f32 v25, v25, v30
  v_sub_f32 v26, v26, v30
  v_sub_f32 v27, v27, v30
  v_sub_f32 v28, v28, v30
  v_sub_f32 v29, v29, v30
  v_cvt_pk_bf16_f32 v35, v20, v21
  v_lshlrev_b32 v20, 16, v35
  v_and_b32 v21, 0xffff0000, v35
  v_cvt_pk_bf16_f32 v35, v22, v23
  v_lshlrev_b32 v22, 16, v35
  v_and_b32 v23, 0xffff0000, v35
  v_cvt_pk_bf16_f32 v35, v24, v25
  v_lshlrev_b32 v24, 16, v35
  v_and_b32 v25, 0xffff0000, v35
  v_cvt_pk_bf16_f32 v35, v26, v27
  v_lshlrev_b32 v26, 16, v35
  v_and_b32 v27, 0xffff0000, v35
  v_cvt_pk_bf16_f32 v35, v28, v29
  v_lshlrev_b32 v28, 16, v35
  v_and_b32 v29, 0xffff0000, v35
  v_mul_f32 v35, v20, v34
  v_fma_f32 v36, -v35, v33, v20
  v_fma_f32 v20, v36, v34, v35
  v_mul_f32 v35, v21, v34
  v_fma_f32 v36, -v35, v33, v21
  v_fma_f32 v21, v36, v34, v35
  v_mul_f32 v35, v22, v34
  v_fma_f32 v36, -v35, v33, v22
  v_fma_f32 v22, v36, v34, v35
  v_mul_f32 v35, v23, v34
  v_fma_f32 v36, -v35, v33, v23
  v_fma_f32 v23, v36, v34, v35
  v_mul_f32 v35, v24, v34
  v_fma_f32 v36, -v35, v33, v24
  v_fma_f32 v24, v36, v34, v35
  v_mul_f32 v35, v25, v34
  v_fma_f32 v36, -v35, v33, v25
  v_fma_f32 v25, v36, v34, v35
  v_mul_f32 v35, v26, v34
  v_fma_f32 v36, -v35, v33, v26
  v_fma_f32 v26, v36, v34, v35
  v_mul_f32 v35, v27, v34
  v_fma_f32 v36, -v35, v33, v27
  v_fma_f32 v27, v36, v34, v35
  v_mul_f32 v35, v28, v34
  v_fma_f32 v36, -v35, v33, v28
  v_fma_f32 v28, v36, v34, v35
  v_mul_f32 v35, v29, v34
  v_fma_f32 v36, -v35, v33, v29
  v_fma_f32 v29, v36, v34, v35
  s_mul_i32 s40, s31, 1344
  v_lshl_add_u32 v3, v1, 2, s40
  v_cvt_pk_bf16_f32 v35, v20, v21
  ds_write_b32 v3, v35 offset:0
  v_cvt_pk_bf16_f32 v35, v22, v23
  ds_write_b32 v3, v35 offset:256
  v_cvt_pk_bf16_f32 v35, v24, v25
  ds_write_b32 v3, v35 offset:512
  v_cvt_pk_bf16_f32 v35, v26, v27
  ds_write_b32 v3, v35 offset:768
  v_cvt_pk_bf16_f32 v35, v28, v29
  ds_write_b32 v3, v35 offset:1024
  s_waitcnt vmcnt(0)
  s_waitcnt lgkmcnt(0)
  s_barrier
  v_lshrrev_b32 v2, 2, v1
  v_bfe_u32 v3, v1, 1, 1
  s_lshl_b32 s40, s31, 1
  v_or_b32 v3, s40, v3
  v_and_b32 v41, 6, v2
  v_xor_b32 v3, v3, v41
  v_lshlrev_b32 v3, 4, v3
  v_lshl_add_u32 v3, v2, 7, v3
  v_and_b32 v41, 1, v1
  v_lshl_add_u32 v41, v41, 3, v3
  v_add_u32 v41, 20480, v41
  v_and_b32 v2, 3, v1
  s_mov_b32 s40, 1344
  v_mul_u32_u24 v45, s40, v2
  v_lshrrev_b32 v2, 4, v1
  v_lshl_add_u32 v45, v2, 3, v45
  s_lshl_b32 s40, s42, 1
  s_add_u32 s40, s40, 0
  v_add_u32 v45, s40, v45
  v_mov_b32 v48, 0
  v_mov_b32 v49, 0
  v_mov_b32 v50, 0
  v_mov_b32 v51, 0
  ds_read_b64 v[60:61], v45 offset:0
  ds_read_b64 v[62:63], v45 offset:32
  ds_read_b64_tr_b16 v[64:65], v41 offset:0
  ds_read_b64_tr_b16 v[66:67], v41 offset:2048
  ds_read_b64 v[68:69], v45 offset:64
  ds_read_b64 v[70:71], v45 offset:96
  ds_read_b64_tr_b16 v[72:73], v41 offset:4096
  ds_read_b64_tr_b16 v[74:75], v41 offset:6144
  ds_read_b64 v[76:77], v45 offset:128
  ds_read_b64 v[78:79], v45 offset:160
  ds_read_b64_tr_b16 v[80:81], v41 offset:8192
  ds_read_b64_tr_b16 v[82:83], v41 offset:10240
  ds_read_b64 v[84:85], v45 offset:192
  ds_read_b64 v[86:87], v45 offset:224
  ds_read_b64_tr_b16 v[88:89], v41 offset:12288
  ds_read_b64_tr_b16 v[90:91], v41 offset:14336
  ds_read_b64 v[92:93], v45 offset:256
  ds_read_b64 v[94:95], v45 offset:288
  ds_read_b64_tr_b16 v[96:97], v41 offset:16384
  ds_read_b64_tr_b16 v[98:99], v41 offset:18432
  ds_read_b64 v[100:101], v45 offset:320
  ds_read_b64 v[102:103], v45 offset:352
  ds_read_b64_tr_b16 v[104:105], v41 offset:20480
  ds_read_b64_tr_b16 v[106:107], v41 offset:22528
  ds_read_b64 v[108:109], v45 offset:384
  ds_read_b64 v[110:111], v45 offset:416
  ds_read_b64_tr_b16 v[112:113], v41 offset:24576
  ds_read_b64_tr_b16 v[114:115], v41 offset:26624
  ds_read_b64 v[116:117], v45 offset:448
  ds_read_b64 v[118:119], v45 offset:480
  ds_read_b64_tr_b16 v[120:121], v41 offset:28672
  ds_read_b64_tr_b16 v[122:123], v41 offset:30720
  ds_read_b64 v[124:125], v45 offset:512
  ds_read_b64 v[126:127], v45 offset:544
  ds_read_b64_tr_b16 v[128:129], v41 offset:32768
  ds_read_b64_tr_b16 v[130:131], v41 offset:34816
  ds_read_b64 v[132:133], v45 offset:576
  ds_read_b64 v[134:135], v45 offset:608
  ds_read_b64_tr_b16 v[136:137], v41 offset:36864
  ds_read_b64_tr_b16 v[138:139], v41 offset:38912
  s_waitcnt lgkmcnt(0)
  v_mfma_f32_16x16x32_bf16 v[48:51], v[60:63], v[64:67], v[48:51]
  v_mfma_f32_16x16x32_bf16 v[48:51], v[68:71], v[72:75], v[48:51]
  v_mfma_f32_16x16x32_bf16 v[48:51], v[76:79], v[80:83], v[48:51]
  v_mfma_f32_16x16x32_bf16 v[48:51], v[84:87], v[88:91], v[48:51]
  v_mfma_f32_16x16x32_bf16 v[48:51], v[92:95], v[96:99], v[48:51]
  v_mfma_f32_16x16x32_bf16 v[48:51], v[100:103], v[104:107], v[48:51]
  v_mfma_f32_16x16x32_bf16 v[48:51], v[108:111], v[112:115], v[48:51]
  v_mfma_f32_16x16x32_bf16 v[48:51], v[116:119], v[120:123], v[48:51]
  v_mfma_f32_16x16x32_bf16 v[48:51], v[124:127], v[128:131], v[48:51]
  v_mfma_f32_16x16x32_bf16 v[48:51], v[132:135], v[136:139], v[48:51]
  v_lshrrev_b32 v46, 4, v1
  s_nop 6
  v_mov_b32 v52, v48
  v_cmp_eq_u32 vcc, 1, v46
  s_nop 1
  v_cndmask_b32 v52, v52, v49, vcc
  v_cmp_eq_u32 vcc, 2, v46
  s_nop 1
  v_cndmask_b32 v52, v52, v50, vcc
  v_cmp_eq_u32 vcc, 3, v46
  s_nop 1
  v_cndmask_b32 v52, v52, v51, vcc
  s_mul_i32 s44, s28, 12288
  s_mul_i32 s45, s41, 6144
  s_add_u32 s44, s44, s45
  s_lshl_b32 s45, s43, 9
  s_add_u32 s44, s44, s45
  s_lshl_b32 s45, s31, 7
  s_add_u32 s44, s44, s45
  s_add_u32 s44, s44, 65536
  v_mul_u32_u24 v2, 1536, v46
  v_and_b32 v3, 14, v1
  v_lshl_add_u32 v6, v3, 3, v2
  v_add_u32 v6, s44, v6
  v_mov_b32_dpp v55, v52 quad_perm:[1,0,3,2] row_mask:0xf bank_mask:0xf
  v_mov_b32 v56, v52
  v_mov_b32 v57, s60
  v_mov_b32 v58, v55
  v_mov_b32 v59, s61
  s_mov_b32 exec_lo, 0x55555555
  s_mov_b32 exec_hi, 0x55555555
  global_store_dwordx4 v6, v[56:59], s[26:27] sc1
  s_mov_b64 exec, -1
  v_cmp_gt_u32 vcc, 96, v0
  s_nop 0
  s_and_saveexec_b64 s[80:81], vcc
  s_cbranch_execz L_qg_2
  s_mul_i32 s82, s28, 12288
  s_mul_i32 s83, s55, 1536
  s_add_u32 s82, s82, s83
  s_add_u32 s82, s82, 65536
  v_lshl_add_u32 v12, v0, 4, s82
  v_add_u32 v13, 6144, v12
  s_mov_b32 s79, 32768
L_poll_3:
  global_load_dwordx4 v[16:19], v12, s[26:27] sc1
  global_load_dwordx4 v[20:23], v13, s[26:27] sc1
  s_waitcnt vmcnt(0)
  v_xor_b32 v7, s60, v17
  v_xor_b32 v8, s61, v19
  v_or_b32 v9, v7, v8
  v_xor_b32 v7, s60, v21
  v_xor_b32 v8, s61, v23
  v_or3_b32 v9, v9, v7, v8
  v_cmp_ne_u32 vcc, 0, v9
  s_nop 0
  s_cmp_lg_u64 vcc, 0
  s_cbranch_scc0 L_pollx_4
  s_sleep 1
  s_sub_u32 s79, s79, 1
  s_cbranch_scc0 L_poll_3
  v_mov_b32 v2, 8
  v_mov_b32 v3, 1
  global_store_dword v2, v3, s[24:25]
L_pollx_4:
  v_add_f32 v16, v16, v20
  v_add_f32 v18, v18, v22
  v_cvt_pk_bf16_f32 v16, v16, v18
  v_lshlrev_b32 v12, 2, v0
  ds_write_b32 v12, v16 offset:5440
L_qg_2:
  s_mov_b64 exec, s[80:81]
  s_waitcnt lgkmcnt(0)
  s_barrier
  s_cmp_ge_u32 s30, 5
  s_cbranch_scc1 A_f2
  s_mov_b32 s36, s12
  s_mov_b32 s37, s13
  s_mov_b32 s38, 7864320
  s_mov_b32 s39, 0x20000
  v_lshrrev_b32 v2, 3, v1
  v_and_b32 v3, 6, v2
  v_and_b32 v40, 7, v1
  v_xor_b32 v40, v40, v3
  v_lshlrev_b32 v40, 4, v40
  s_mov_b32 s40, 1280
  v_mad_u32_u24 v40, v2, s40, v40
  s_mul_i32 s44, s28, 245760
  s_lshl_b32 s45, s30, 8
  s_add_u32 s44, s44, s45
  s_mul_i32 s45, s31, 10240
  s_add_u32 s44, s44, s45
  s_lshl_b32 s45, s31, 10
  s_add_u32 s45, s45, 20480
  s_add_u32 s46, s44, 0
  s_add_u32 s47, s45, 0
  s_mov_b32 m0, s47
  s_nop 0
  buffer_load_dwordx4 v40, s[36:39], s46 offen nt lds
  s_add_u32 s46, s44, 40960
  s_add_u32 s47, s45, 4096
  s_mov_b32 m0, s47
  s_nop 0
  buffer_load_dwordx4 v40, s[36:39], s46 offen nt lds
  s_add_u32 s46, s44, 81920
  s_add_u32 s47, s45, 8192
  s_mov_b32 m0, s47
  s_nop 0
  buffer_load_dwordx4 v40, s[36:39], s46 offen nt lds
  s_add_u32 s46, s44, 122880
  s_add_u32 s47, s45, 12288
  s_mov_b32 m0, s47
  s_nop 0
  buffer_load_dwordx4 v40, s[36:39], s46 offen nt lds
  s_add_u32 s46, s44, 163840
  s_add_u32 s47, s45, 16384
  s_mov_b32 m0, s47
  s_nop 0
  buffer_load_dwordx4 v40, s[36:39], s46 offen nt lds
  s_add_u32 s46, s44, 204800
  s_add_u32 s47, s45, 20480
  s_mov_b32 m0, s47
  s_nop 0
  buffer_load_dwordx4 v40, s[36:39], s46 offen nt lds
  s_add_u32 s46, s44, 128
  s_add_u32 s47, s45, 24576
  s_mov_b32 m0, s47
  s_nop 0
  buffer_load_dwordx4 v40, s[36:39], s46 offen nt lds
  s_add_u32 s46, s44, 41088
  s_add_u32 s47, s45, 28672
  s_mov_b32 m0, s47
  s_nop 0
  buffer_load_dwordx4 v40, s[36:39], s46 offen nt lds
  s_add_u32 s46, s44, 82048
  s_add_u32 s47, s45, 32768
  s_mov_b32 m0, s47
  s_nop 0
  buffer_load_dwordx4 v40, s[36:39], s46 offen nt lds
  s_add_u32 s46, s44, 123008
  s_add_u32 s47, s45, 36864
  s_mov_b32 m0, s47
  s_nop 0
  buffer_load_dwordx4 v40, s[36:39], s46 offen nt lds
  s_add_u32 s46, s44, 163968
  s_add_u32 s47, s45, 40960
  s_mov_b32 m0, s47
  s_nop 0
  buffer_load_dwordx4 v40, s[36:39], s46 offen nt lds
  s_add_u32 s46, s44, 204928
  s_add_u32 s47, s45, 45056
  s_mov_b32 m0, s47
  s_nop 0
  buffer_load_dwordx4 v40, s[36:39], s46 offen nt lds
  s_waitcnt vmcnt(0)
  s_waitcnt lgkmcnt(0)
  s_add_u32 s58, s58, 4
  v_mov_b32 v2, 5376
  v_mov_b32 v3, 1
  s_mov_b64 exec, 1
  ds_add_u32 v2, v3
  s_mov_b64 exec, -1
  s_mov_b32 s79, 524288
L_ab_5:
  ds_read_b32 v4, v2
  s_waitcnt lgkmcnt(0)
  v_readfirstlane_b32 s78, v4
  s_nop 0
  s_cmp_ge_u32 s78, s58
  s_cbranch_scc1 L_abx_6
  s_sleep 1
  s_sub_u32 s79, s79, 1
  s_cbranch_scc0 L_ab_5
  v_mov_b32 v2, 4
  v_mov_b32 v3, 1
  global_store_dword v2, v3, s[24:25]
L_abx_6:
  v_lshrrev_b32 v2, 2, v1
  v_bfe_u32 v3, v1, 1, 1
  s_lshl_b32 s40, s31, 1
  v_or_b32 v3, s40, v3
  v_and_b32 v41, 6, v2
  v_xor_b32 v3, v3, v41
  v_lshlrev_b32 v3, 4, v3
  v_lshl_add_u32 v3, v2, 7, v3
  v_and_b32 v41, 1, v1
  v_lshl_add_u32 v41, v41, 3, v3
  v_add_u32 v41, 20480, v41
  ds_read_b64_tr_b16 v[160:161], v41 offset:0
  ds_read_b64_tr_b16 v[162:163], v41 offset:2048
  ds_read_b64_tr_b16 v[164:165], v41 offset:4096
  ds_read_b64_tr_b16 v[166:167], v41 offset:6144
  ds_read_b64_tr_b16 v[168:169], v41 offset:8192
  ds_read_b64_tr_b16 v[170:171], v41 offset:10240
  ds_read_b64_tr_b16 v[172:173], v41 offset:12288
  ds_read_b64_tr_b16 v[174:175], v41 offset:14336
  ds_read_b64_tr_b16 v[176:177], v41 offset:16384
  ds_read_b64_tr_b16 v[178:179], v41 offset:18432
  ds_read_b64_tr_b16 v[180:181], v41 offset:20480
  ds_read_b64_tr_b16 v[182:183], v41 offset:22528
  ds_read_b64_tr_b16 v[184:185], v41 offset:24576
  ds_read_b64_tr_b16 v[186:187], v41 offset:26624
  ds_read_b64_tr_b16 v[188:189], v41 offset:28672
  ds_read_b64_tr_b16 v[190:191], v41 offset:30720
  ds_read_b64_tr_b16 v[192:193], v41 offset:32768
  ds_read_b64_tr_b16 v[194:195], v41 offset:34816
  ds_read_b64_tr_b16 v[196:197], v41 offset:36864
  ds_read_b64_tr_b16 v[198:199], v41 offset:38912
  ds_read_b64_tr_b16 v[200:201], v41 offset:40960
  ds_read_b64_tr_b16 v[202:203], v41 offset:43008
  ds_read_b64_tr_b16 v[204:205], v41 offset:45056
  ds_read_b64_tr_b16 v[206:207], v41 offset:47104
  s_waitcnt lgkmcnt(0)
A_tail:
  s_cmp_ge_u32 s30, 5
  s_cbranch_scc1 L_nog_8
  s_cmp_lg_u32 s31, 0
  s_cbranch_scc1 L_nog_8
  s_lshr_b32 s50, s28, 3
  s_and_b32 s51, s28, 7
  s_lshl_b32 s44, s30, 1
  s_lshr_b32 s45, s51, 2
  s_add_u32 s44, s44, s45
  s_mul_i32 s44, s44, 3072
  s_lshl_b32 s45, s50, 8
  s_add_u32 s44, s44, s45
  s_and_b32 s45, s51, 3
  s_lshl_b32 s45, s45, 6
  s_add_u32 s44, s44, s45
  s_add_u32 s44, s44, 1081344
  v_lshrrev_b32 v10, 2, v1
  v_lshlrev_b32 v10, 10, v10
  v_and_b32 v11, 3, v1
  v_lshl_add_u32 v10, v11, 4, v10
  v_add_u32 v10, s44, v10
  v_mov_b32 v16, 0
  v_mov_b32 v17, 0
  v_mov_b32 v18, 0
  v_mov_b32 v19, 0
  s_mov_b64 exec, 0xfff
  s_mov_b32 s79, 32768
L_poll_9:
  global_load_dwordx4 v[16:19], v10, s[26:27] sc1
  s_waitcnt vmcnt(0)
  v_xor_b32 v9, v159, v16
  v_xor_b32 v7, v159, v17
  v_xor_b32 v8, v159, v18
  v_or3_b32 v9, v9, v7, v8
  v_xor_b32 v7, v159, v19
  v_or_b32 v9, v9, v7
  v_and_b32 v9, 0x3ff, v9
  v_cmp_ne_u32 vcc, 0, v9
  s_nop 0
  s_cmp_lg_u64 vcc, 0
  s_cbranch_scc0 L_pollx_10
  s_sleep 32
  s_sub_u32 s79, s79, 1
  s_cbranch_scc0 L_poll_9
  v_mov_b32 v2, 12
  v_mov_b32 v3, 1
  global_store_dword v2, v3, s[24:25]
L_pollx_10:
  v_and_b32 v16, 0xfffffc00, v16
  v_and_b32 v17, 0xfffffc00, v17
  v_and_b32 v18, 0xfffffc00, v18
  v_and_b32 v19, 0xfffffc00, v19
  s_mov_b64 exec, -1
  v_mov_b32 v150, v16
  v_mov_b32 v151, v17
  v_mov_b32 v152, v18
  v_mov_b32 v153, v19
  v_add_f32_dpp v150, v150, v150 row_ror:8 row_mask:0xf bank_mask:0xf
  v_add_f32_dpp v151, v151, v151 row_ror:8 row_mask:0xf bank_mask:0xf
  v_add_f32_dpp v152, v152, v152 row_ror:8 row_mask:0xf bank_mask:0xf
  v_add_f32_dpp v153, v153, v153 row_ror:8 row_mask:0xf bank_mask:0xf
  v_add_f32_dpp v150, v150, v150 row_ror:4 row_mask:0xf bank_mask:0xf
  v_add_f32_dpp v151, v151, v151 row_ror:4 row_mask:0xf bank_mask:0xf
  v_add_f32_dpp v152, v152, v152 row_ror:4 row_mask:0xf bank_mask:0xf
  v_add_f32_dpp v153, v153, v153 row_ror:4 row_mask:0xf bank_mask:0xf
  v_mov_b32 v7, v150
  s_nop 1
  v_permlane16_swap_b32 v150, v7
  v_add_f32 v150, v150, v7
  v_mov_b32 v7, v151
  s_nop 1
  v_permlane16_swap_b32 v151, v7
  v_add_f32 v151, v151, v7
  v_mov_b32 v7, v152
  s_nop 1
  v_permlane16_swap_b32 v152, v7
  v_add_f32 v152, v152, v7
  v_mov_b32 v7, v153
  s_nop 1
  v_permlane16_swap_b32 v153, v7
  v_add_f32 v153, v153, v7
  v_mov_b32 v7, v150
  s_nop 1
  v_permlane32_swap_b32 v150, v7
  v_add_f32 v150, v150, v7
  v_mov_b32 v7, v151
  s_nop 1
  v_permlane32_swap_b32 v151, v7
  v_add_f32 v151, v151, v7
  v_mov_b32 v7, v152
  s_nop 1
  v_permlane32_swap_b32 v152, v7
  v_add_f32 v152, v152, v7
  v_mov_b32 v7, v153
  s_nop 1
  v_permlane32_swap_b32 v153, v7
  v_add_f32 v153, v153, v7
  v_cvt_pk_bf16_f32 v150, v150, v150
  v_and_b32 v150, 0xffff0000, v150
  v_mul_f32 v20, 0xbfb8aa3b, v150
  v_exp_f32 v20, v20
  s_nop 0
  v_add_f32 v20, 1.0, v20
  v_rcp_f32 v21, v20
  s_nop 0
  v_mul_f32 v22, v150, v21
  v_fma_f32 v23, -v22, v20, v150
  v_fma_f32 v22, v23, v21, v22
  v_mul_f32 v23, v150, v21
  v_cmp_u_f32 vcc, v22, v22
  s_nop 1
  v_cndmask_b32 v22, v22, v23, vcc
  v_cvt_pk_bf16_f32 v150, v22, v22
  v_and_b32 v150, 0xffff0000, v150
  v_cvt_pk_bf16_f32 v151, v151, v151
  v_and_b32 v151, 0xffff0000, v151
  v_mul_f32 v20, 0xbfb8aa3b, v151
  v_exp_f32 v20, v20
  s_nop 0
  v_add_f32 v20, 1.0, v20
  v_rcp_f32 v21, v20
  s_nop 0
  v_mul_f32 v22, v151, v21
  v_fma_f32 v23, -v22, v20, v151
  v_fma_f32 v22, v23, v21, v22
  v_mul_f32 v23, v151, v21
  v_cmp_u_f32 vcc, v22, v22
  s_nop 1
  v_cndmask_b32 v22, v22, v23, vcc
  v_cvt_pk_bf16_f32 v151, v22, v22
  v_and_b32 v151, 0xffff0000, v151
  v_cvt_pk_bf16_f32 v152, v152, v152
  v_and_b32 v152, 0xffff0000, v152
  v_mul_f32 v20, 0xbfb8aa3b, v152
  v_exp_f32 v20, v20
  s_nop 0
  v_add_f32 v20, 1.0, v20
  v_rcp_f32 v21, v20
  s_nop 0
  v_mul_f32 v22, v152, v21
  v_fma_f32 v23, -v22, v20, v152
  v_fma_f32 v22, v23, v21, v22
  v_mul_f32 v23, v152, v21
  v_cmp_u_f32 vcc, v22, v22
  s_nop 1
  v_cndmask_b32 v22, v22, v23, vcc
  v_cvt_pk_bf16_f32 v152, v22, v22
  v_and_b32 v152, 0xffff0000, v152
  v_cvt_pk_bf16_f32 v153, v153, v153
  v_and_b32 v153, 0xffff0000, v153
  v_mul_f32 v20, 0xbfb8aa3b, v153
  v_exp_f32 v20, v20
  s_nop 0
  v_add_f32 v20, 1.0, v20
  v_rcp_f32 v21, v20
  s_nop 0
  v_mul_f32 v22, v153, v21
  v_fma_f32 v23, -v22, v20, v153
  v_fma_f32 v22, v23, v21, v22
  v_mul_f32 v23, v153, v21
  v_cmp_u_f32 vcc, v22, v22
  s_nop 1
  v_cndmask_b32 v22, v22, v23, vcc
  v_cvt_pk_bf16_f32 v153, v22, v22
  v_and_b32 v153, 0xffff0000, v153
  s_lshl_b32 s44, s30, 7
  s_lshl_b32 s45, s51, 4
  s_add_u32 s44, s44, s45
  s_mul_i32 s45, s50, 640
  s_add_u32 s44, s44, s45
  s_lshl_b32 s44, s44, 1
  v_and_b32 v158, 3, v1
  v_lshl_add_u32 v158, v158, 3, s44
  global_load_dwordx2 v[154:155], v158, s[4:5]
  s_waitcnt vmcnt(0)
  v_and_b32 v157, 0xffff0000, v155
  v_lshlrev_b32 v156, 16, v155
  v_and_b32 v155, 0xffff0000, v154
  v_lshlrev_b32 v154, 16, v154
L_nog_8:
  s_lshl_b32 s40, s28, 2
  s_add_u32 s40, s40, s55
  s_lshl_b32 s40, s40, 1
  s_add_u32 s40, s40, s59
  s_lshl_b32 s40, s40, 10
  s_add_u32 s40, s40, 458752
  v_lshl_add_u32 v6, v1, 4, s40
  v_min_u32 v5, 48, v1
  v_lshlrev_b32 v5, 4, v5
  v_mov_b32 v3, 0
  s_barrier
  s_cmp_lg_u32 s31, 0
  s_cbranch_scc1 L_s2x_11
  ds_read_b64 v[28:29], v3 offset:8448
  ds_read_b64 v[30:31], v3 offset:9248
  ds_read_b64 v[32:33], v3 offset:10048
  ds_read_b64 v[34:35], v3 offset:10848
  ds_read_b128 v[12:15], v5 offset:7680
  ds_read_b128 v[16:19], v5 offset:8480
  ds_read_b128 v[20:23], v5 offset:9280
  ds_read_b128 v[24:27], v5 offset:10080
  s_waitcnt lgkmcnt(4)
  v_max_f32 v36, v28, v30
  v_max3_f32 v36, v36, v32, v34
  v_sub_f32 v28, v28, v36
  v_exp_f32 v28, v28
  v_sub_f32 v30, v30, v36
  v_exp_f32 v30, v30
  v_sub_f32 v32, v32, v36
  v_exp_f32 v32, v32
  v_sub_f32 v34, v34, v36
  v_exp_f32 v34, v34
  v_mul_f32 v37, v29, v28
  v_fmac_f32 v37, v31, v30
  v_fmac_f32 v37, v33, v32
  v_fmac_f32 v37, v35, v34
  s_waitcnt lgkmcnt(0)
  v_mul_f32 v40, v12, v28
  v_fmac_f32 v40, v16, v30
  v_fmac_f32 v40, v20, v32
  v_fmac_f32 v40, v24, v34
  v_mul_f32 v41, v13, v28
  v_fmac_f32 v41, v17, v30
  v_fmac_f32 v41, v21, v32
  v_fmac_f32 v41, v25, v34
  v_mul_f32 v42, v14, v28
  v_fmac_f32 v42, v18, v30
  v_fmac_f32 v42, v22, v32
  v_fmac_f32 v42, v26, v34
  v_mul_f32 v43, v15, v28
  v_fmac_f32 v43, v19, v30
  v_fmac_f32 v43, v23, v32
  v_fmac_f32 v43, v27, v34
  v_and_b32 v38, 0xffff0000, v36
  v_lshlrev_b32 v39, 16, v36
  v_cmp_eq_u32 vcc, 48, v1
  s_nop 1
  v_cndmask_b32 v40, v40, v38, vcc
  v_cndmask_b32 v41, v41, v37, vcc
  v_cndmask_b32 v42, v42, v39, vcc
  v_add_u32 v44, 0x200, v40
  v_bfi_b32 v44, s57, v159, v44
  v_add_u32 v45, 0x200, v41
  v_bfi_b32 v45, s57, v159, v45
  v_add_u32 v46, 0x200, v42
  v_bfi_b32 v46, s57, v159, v46
  v_add_u32 v47, 0x200, v43
  v_bfi_b32 v47, s57, v159, v47
  s_mov_b32 exec_hi, 0x1ffff
  global_store_dwordx4 v6, v[44:47], s[26:27] sc1
  s_mov_b64 exec, -1
L_s2x_11:
  s_cmp_ge_u32 s30, 5
  s_cbranch_scc1 L_tail_done_7
  s_lshl_b32 s40, s28, 2
  s_add_u32 s40, s40, s31
  s_lshl_b32 s40, s40, 11
  s_add_u32 s40, s40, 458752
  v_min_u32 v5, 48, v1
  v_lshl_add_u32 v10, v5, 4, s40
  v_lshrrev_b32 v4, 4, v1
  v_lshlrev_b32 v4, 6, v4
  v_and_b32 v6, 1, v1
  v_lshl_add_u32 v4, v6, 5, v4
  v_bfe_u32 v6, v1, 1, 3
  v_add_u32 v4, v4, v6
  v_lshlrev_b32 v4, 1, v4
  s_mul_i32 s41, s31, 400
  v_add_u32 v47, s41, v4
  s_mov_b32 s79, 32768
L_poll_12:
  global_load_dwordx4 v[20:23], v10, s[26:27] sc1
  global_load_dwordx4 v[24:27], v10, s[26:27] offset:1024 sc1
  s_waitcnt vmcnt(0)
  v_xor_b32 v9, v159, v20
  v_xor_b32 v7, v159, v21
  v_xor_b32 v8, v159, v22
  v_or3_b32 v9, v9, v7, v8
  v_xor_b32 v7, v159, v23
  v_xor_b32 v8, v159, v24
  v_or3_b32 v9, v9, v7, v8
  v_xor_b32 v7, v159, v25
  v_xor_b32 v8, v159, v26
  v_or3_b32 v9, v9, v7, v8
  v_xor_b32 v7, v159, v27
  v_or_b32 v9, v9, v7
  v_and_b32 v9, 0x3ff, v9
  v_cmp_ne_u32 vcc, 0, v9
  s_nop 0
  s_cmp_lg_u64 vcc, 0
  s_cbranch_scc0 L_pollx_13
  s_sleep 1
  s_sub_u32 s79, s79, 1
  s_cbranch_scc0 L_poll_12
  v_mov_b32 v2, 20
  v_mov_b32 v3, 1
  global_store_dword v2, v3, s[24:25]
L_pollx_13:
  v_and_b32 v20, 0xfffffc00, v20
  v_and_b32 v21, 0xfffffc00, v21
  v_and_b32 v22, 0xfffffc00, v22
  v_and_b32 v23, 0xfffffc00, v23
  v_and_b32 v24, 0xfffffc00, v24
  v_and_b32 v25, 0xfffffc00, v25
  v_and_b32 v26, 0xfffffc00, v26
  v_and_b32 v27, 0xfffffc00, v27
  v_readlane_b32 s40, v20, 48
  v_readlane_b32 s41, v21, 48
  v_readlane_b32 s42, v24, 48
  v_readlane_b32 s43, v25, 48
  v_readlane_b32 s44, v22, 48
  v_readlane_b32 s45, v26, 48
  s_lshr_b32 s44, s44, 16
  s_lshr_b32 s45, s45, 16
  s_or_b32 s40, s40, s44
  s_or_b32 s42, s42, s45
  v_mov_b32 v30, s40
  v_mov_b32 v31, s42
  v_max_f32 v32, v30, v31
  v_sub_f32 v30, v30, v32
  v_sub_f32 v31, v31, v32
  v_exp_f32 v30, v30
  v_exp_f32 v31, v31
  v_mul_f32 v33, s41, v30
  v_fmac_f32 v33, s43, v31
  v_rcp_f32 v34, v33
  v_mul_f32 v20, v20, v30
  v_fmac_f32 v20, v24, v31
  v_mul_f32 v21, v21, v30
  v_fmac_f32 v21, v25, v31
  v_mul_f32 v22, v22, v30
  v_fmac_f32 v22, v26, v31
  v_mul_f32 v23, v23, v30
  v_fmac_f32 v23, v27, v31
  v_mul_f32 v9, v20, v34
  v_fma_f32 v8, -v9, v33, v20
  v_fma_f32 v20, v8, v34, v9
  v_mul_f32 v9, v21, v34
  v_fma_f32 v8, -v9, v33, v21
  v_fma_f32 v21, v8, v34, v9
  v_mul_f32 v9, v22, v34
  v_fma_f32 v8, -v9, v33, v22
  v_fma_f32 v22, v8, v34, v9
  v_mul_f32 v9, v23, v34
  v_fma_f32 v8, -v9, v33, v23
  v_fma_f32 v23, v8, v34, v9
  v_cvt_pk_bf16_f32 v20, v20, v21
  v_cvt_pk_bf16_f32 v22, v22, v23
  s_mov_b32 exec_hi, 0xffff
  ds_write_b16 v47, v20 offset:5888
  ds_write_b16_d16_hi v47, v20 offset:5904
  ds_write_b16 v47, v22 offset:5920
  ds_write_b16_d16_hi v47, v22 offset:5936
  s_mov_b64 exec, -1
  v_and_b32 v2, 3, v1
  s_mov_b32 s40, 400
  v_mul_u32_u24 v45, s40, v2
  v_lshrrev_b32 v2, 4, v1
  v_lshl_add_u32 v45, v2, 3, v45
  v_add_u32 v45, 5888, v45
  s_lshl_b32 s40, s30, 16
  s_lshl_b32 s41, s28, 9
  s_add_u32 s40, s40, s41
  s_lshl_b32 s41, s31, 6
  s_add_u32 s40, s40, s41
  s_add_u32 s40, s40, 720896
  v_and_b32 v10, 3, v1
  v_lshlrev_b32 v10, 14, v10
  v_lshrrev_b32 v11, 4, v1
  v_lshl_add_u32 v10, v11, 4, v10
  v_bfe_u32 v11, v1, 2, 1
  v_lshl_add_u32 v10, v11, 8, v10
  v_add_u32 v46, s40, v10
  v_mov_b32 v44, v11
  s_waitcnt lgkmcnt(0)
  s_barrier
  ds_read_b64 v[60:61], v45 offset:0
  ds_read_b64 v[62:63], v45 offset:32
  ds_read_b64 v[64:65], v45 offset:64
  ds_read_b64 v[66:67], v45 offset:96
  ds_read_b64 v[68:69], v45 offset:128
  ds_read_b64 v[70:71], v45 offset:160
  ds_read_b64 v[72:73], v45 offset:192
  ds_read_b64 v[74:75], v45 offset:224
  ds_read_b64 v[76:77], v45 offset:256
  ds_read_b64 v[78:79], v45 offset:288
  ds_read_b64 v[80:81], v45 offset:320
  ds_read_b64 v[82:83], v45 offset:352
  s_waitcnt lgkmcnt(10)
  v_mfma_f32_16x16x32_bf16 v[48:51], v[160:163], v[60:63], 0
  v_mfma_f32_16x16x32_bf16 v[52:55], v[184:187], v[60:63], 0
  s_waitcnt lgkmcnt(8)
  v_mfma_f32_16x16x32_bf16 v[48:51], v[164:167], v[64:67], v[48:51]
  v_mfma_f32_16x16x32_bf16 v[52:55], v[188:191], v[64:67], v[52:55]
  s_waitcnt lgkmcnt(6)
  v_mfma_f32_16x16x32_bf16 v[48:51], v[168:171], v[68:71], v[48:51]
  v_mfma_f32_16x16x32_bf16 v[52:55], v[192:195], v[68:71], v[52:55]
  s_waitcnt lgkmcnt(4)
  v_mfma_f32_16x16x32_bf16 v[48:51], v[172:175], v[72:75], v[48:51]
  v_mfma_f32_16x16x32_bf16 v[52:55], v[196:199], v[72:75], v[52:55]
  s_waitcnt lgkmcnt(2)
  v_mfma_f32_16x16x32_bf16 v[48:51], v[176:179], v[76:79], v[48:51]
  v_mfma_f32_16x16x32_bf16 v[52:55], v[200:203], v[76:79], v[52:55]
  s_waitcnt lgkmcnt(0)
  v_mfma_f32_16x16x32_bf16 v[48:51], v[180:183], v[80:83], v[48:51]
  v_mfma_f32_16x16x32_bf16 v[52:55], v[204:207], v[80:83], v[52:55]
  v_cmp_eq_u32 vcc, 1, v44
  s_nop 6
  v_cndmask_b32 v12, v48, v52, vcc
  v_cndmask_b32 v13, v49, v53, vcc
  v_cndmask_b32 v14, v50, v54, vcc
  v_cndmask_b32 v15, v51, v55, vcc
  v_add_u32 v16, 0x200, v12
  v_bfi_b32 v16, s57, v159, v16
  v_add_u32 v17, 0x200, v13
  v_bfi_b32 v17, s57, v159, v17
  v_add_u32 v18, 0x200, v14
  v_bfi_b32 v18, s57, v159, v18
  v_add_u32 v19, 0x200, v15
  v_bfi_b32 v19, s57, v159, v19
  s_mov_b32 exec_lo, 0x00ff00ff
  s_mov_b32 exec_hi, 0x00ff00ff
  global_store_dwordx4 v46, v[16:19], s[26:27] sc1
  s_mov_b64 exec, -1
  s_cmp_lg_u32 s31, 0
  s_cbranch_scc1 L_tail_done_7
  s_lshl_b32 s40, s30, 2
  s_add_u32 s40, s40, s50
  s_lshl_b32 s40, s40, 14
  s_lshl_b32 s41, s51, 6
  s_add_u32 s40, s40, s41
  s_add_u32 s40, s40, 720896
  v_lshrrev_b32 v10, 2, v1
  v_lshlrev_b32 v10, 9, v10
  v_and_b32 v11, 3, v1
  v_lshl_add_u32 v10, v11, 4, v10
  v_add_u32 v10, s40, v10
  v_add_u32 v11, 8192, v10
  s_lshl_b32 s44, s30, 7
  s_lshl_b32 s45, s51, 4
  s_add_u32 s44, s44, s45
  s_mul_i32 s45, s50, 640
  s_add_u32 s44, s44, s45
  s_lshl_b32 s44, s44, 1
  v_and_b32 v158, 3, v1
  v_lshl_add_u32 v158, v158, 3, s44
  s_mov_b32 s79, 32768
L_poll_14:
  global_load_dwordx4 v[16:19], v10, s[26:27] sc1
  global_load_dwordx4 v[20:23], v11, s[26:27] sc1
  s_waitcnt vmcnt(0)
  v_xor_b32 v9, v159, v16
  v_xor_b32 v7, v159, v17
  v_xor_b32 v8, v159, v18
  v_or3_b32 v9, v9, v7, v8
  v_xor_b32 v7, v159, v19
  v_xor_b32 v8, v159, v20
  v_or3_b32 v9, v9, v7, v8
  v_xor_b32 v7, v159, v21
  v_xor_b32 v8, v159, v22
  v_or3_b32 v9, v9, v7, v8
  v_xor_b32 v7, v159, v23
  v_or_b32 v9, v9, v7
  v_and_b32 v9, 0x3ff, v9
  v_cmp_ne_u32 vcc, 0, v9
  s_nop 0
  s_cmp_lg_u64 vcc, 0
  s_cbranch_scc0 L_pollx_15
  s_sleep 1
  s_sub_u32 s79, s79, 1
  s_cbranch_scc0 L_poll_14
  v_mov_b32 v2, 24
  v_mov_b32 v3, 1
  global_store_dword v2, v3, s[24:25]
L_pollx_15:
  v_and_b32 v16, 0xfffffc00, v16
  v_and_b32 v17, 0xfffffc00, v17
  v_and_b32 v18, 0xfffffc00, v18
  v_and_b32 v19, 0xfffffc00, v19
  v_and_b32 v20, 0xfffffc00, v20
  v_and_b32 v21, 0xfffffc00, v21
  v_and_b32 v22, 0xfffffc00, v22
  v_and_b32 v23, 0xfffffc00, v23
  v_add_f32 v16, v16, v20
  v_add_f32 v17, v17, v21
  v_add_f32 v18, v18, v22
  v_add_f32 v19, v19, v23
  v_add_f32_dpp v16, v16, v16 row_ror:8 row_mask:0xf bank_mask:0xf
  v_add_f32_dpp v17, v17, v17 row_ror:8 row_mask:0xf bank_mask:0xf
  v_add_f32_dpp v18, v18, v18 row_ror:8 row_mask:0xf bank_mask:0xf
  v_add_f32_dpp v19, v19, v19 row_ror:8 row_mask:0xf bank_mask:0xf
  v_add_f32_dpp v16, v16, v16 row_ror:4 row_mask:0xf bank_mask:0xf
  v_add_f32_dpp v17, v17, v17 row_ror:4 row_mask:0xf bank_mask:0xf
  v_add_f32_dpp v18, v18, v18 row_ror:4 row_mask:0xf bank_mask:0xf
  v_add_f32_dpp v19, v19, v19 row_ror:4 row_mask:0xf bank_mask:0xf
  v_mov_b32 v7, v16
  s_nop 1
  v_permlane16_swap_b32 v16, v7
  v_add_f32 v16, v16, v7
  v_mov_b32 v7, v17
  s_nop 1
  v_permlane16_swap_b32 v17, v7
  v_add_f32 v17, v17, v7
  v_mov_b32 v7, v18
  s_nop 1
  v_permlane16_swap_b32 v18, v7
  v_add_f32 v18, v18, v7
  v_mov_b32 v7, v19
  s_nop 1
  v_permlane16_swap_b32 v19, v7
  v_add_f32 v19, v19, v7
  v_mov_b32 v7, v16
  s_nop 1
  v_permlane32_swap_b32 v16, v7
  v_add_f32 v16, v16, v7
  v_mov_b32 v7, v17
  s_nop 1
  v_permlane32_swap_b32 v17, v7
  v_add_f32 v17, v17, v7
  v_mov_b32 v7, v18
  s_nop 1
  v_permlane32_swap_b32 v18, v7
  v_add_f32 v18, v18, v7
  v_mov_b32 v7, v19
  s_nop 1
  v_permlane32_swap_b32 v19, v7
  v_add_f32 v19, v19, v7
  v_cvt_pk_bf16_f32 v16, v16, v16
  v_and_b32 v16, 0xffff0000, v16
  v_mul_f32 v16, v16, v150
  v_cvt_pk_bf16_f32 v16, v16, v16
  v_and_b32 v16, 0xffff0000, v16
  v_add_f32 v16, v154, v16
  v_cvt_pk_bf16_f32 v17, v17, v17
  v_and_b32 v17, 0xffff0000, v17
  v_mul_f32 v17, v17, v151
  v_cvt_pk_bf16_f32 v17, v17, v17
  v_and_b32 v17, 0xffff0000, v17
  v_add_f32 v17, v155, v17
  v_cvt_pk_bf16_f32 v18, v18, v18
  v_and_b32 v18, 0xffff0000, v18
  v_mul_f32 v18, v18, v152
  v_cvt_pk_bf16_f32 v18, v18, v18
  v_and_b32 v18, 0xffff0000, v18
  v_add_f32 v18, v156, v18
  v_cvt_pk_bf16_f32 v19, v19, v19
  v_and_b32 v19, 0xffff0000, v19
  v_mul_f32 v19, v19, v153
  v_cvt_pk_bf16_f32 v19, v19, v19
  v_and_b32 v19, 0xffff0000, v19
  v_add_f32 v19, v157, v19
  v_cvt_pk_bf16_f32 v20, v16, v17
  v_cvt_pk_bf16_f32 v21, v18, v19
  s_mov_b64 exec, 0xf
  global_store_dwordx2 v158, v[20:21], s[22:23]
  s_mov_b64 exec, -1
  s_cmp_eq_u32 s28, 0
  s_cbranch_scc0 L_tail_done_7
  s_cmp_eq_u32 s30, 0
  s_cbranch_scc0 L_tail_done_7
  v_mov_b32 v2, 0
  v_mov_b32 v3, s60
  s_mov_b64 exec, 1
  global_store_dword v2, v3, s[26:27] sc1
  s_mov_b64 exec, -1
L_tail_done_7:
  s_endpgm
L_stream:
  s_sub_u32 s31, s31, 4
  s_mov_b32 s32, s6
  s_mov_b32 s33, s7
  s_mov_b32 s34, 201326592
  s_mov_b32 s35, 0x20000
  s_mov_b32 s36, s8
  s_mov_b32 s37, s9
  s_mov_b32 s38, 201326592
  s_mov_b32 s39, 0x20000
  v_lshrrev_b32 v2, 3, v1
  v_and_b32 v3, 7, v1
  v_mul_u32_u24 v2, 384, v2
  v_lshl_add_u32 v10, v3, 4, v2
  s_mul_i32 s52, s28, 1572864
  s_mul_i32 s40, s55, 50331648
  s_add_u32 s52, s52, s40
  s_lshl_b32 s53, s59, 2
  s_add_u32 s53, s53, s31
  s_lshl_b32 s40, s28, 2
  s_add_u32 s40, s40, s55
  s_lshl_b32 s40, s40, 8
  s_add_u32 s40, s40, 4096
  v_mov_b32 v8, s40
  v_mov_b32 v9, 1
  s_mov_b32 s91, 28
  s_lshl_b32 s92, s91, 3
  s_barrier
  s_mul_i32 s54, s53, 6144
  s_add_u32 s54, s54, s52
  s_add_u32 s53, s53, 8
  buffer_load_dwordx4 v[60:63], v10, s[32:35], s54 offen offset:0 nt
  buffer_load_dwordx4 v[64:67], v10, s[32:35], s54 offen offset:128 nt
  buffer_load_dwordx4 v[68:71], v10, s[32:35], s54 offen offset:256 nt
  buffer_load_dwordx4 v[72:75], v10, s[32:35], s54 offen offset:3072 nt
  buffer_load_dwordx4 v[76:79], v10, s[32:35], s54 offen offset:3200 nt
  buffer_load_dwordx4 v[80:83], v10, s[32:35], s54 offen offset:3328 nt
  s_waitcnt vmcnt(3)
  buffer_load_dwordx4 v[84:87], v10, s[36:39], s54 offen offset:0 nt
  buffer_load_dwordx4 v[88:91], v10, s[36:39], s54 offen offset:128 nt
  buffer_load_dwordx4 v[92:95], v10, s[36:39], s54 offen offset:256 nt
  buffer_load_dwordx4 v[96:99], v10, s[36:39], s54 offen offset:3072 nt
  buffer_load_dwordx4 v[100:103], v10, s[36:39], s54 offen offset:3200 nt
  buffer_load_dwordx4 v[104:107], v10, s[36:39], s54 offen offset:3328 nt
  s_mul_i32 s54, s53, 6144
  s_add_u32 s54, s54, s52
  s_add_u32 s53, s53, 8
  s_waitcnt vmcnt(3)
  buffer_load_dwordx4 v[108:111], v10, s[32:35], s54 offen offset:0 nt
  buffer_load_dwordx4 v[112:115], v10, s[32:35], s54 offen offset:128 nt
  buffer_load_dwordx4 v[116:119], v10, s[32:35], s54 offen offset:256 nt
  buffer_load_dwordx4 v[120:123], v10, s[32:35], s54 offen offset:3072 nt
  buffer_load_dwordx4 v[124:127], v10, s[32:35], s54 offen offset:3200 nt
  buffer_load_dwordx4 v[128:131], v10, s[32:35], s54 offen offset:3328 nt
  s_waitcnt vmcnt(3)
  buffer_load_dwordx4 v[132:135], v10, s[36:39], s54 offen offset:0 nt
  buffer_load_dwordx4 v[136:139], v10, s[36:39], s54 offen offset:128 nt
  buffer_load_dwordx4 v[140:143], v10, s[36:39], s54 offen offset:256 nt
  buffer_load_dwordx4 v[144:147], v10, s[36:39], s54 offen offset:3072 nt
  buffer_load_dwordx4 v[148:151], v10, s[36:39], s54 offen offset:3200 nt
  buffer_load_dwordx4 v[152:155], v10, s[36:39], s54 offen offset:3328 nt
  v_mov_b32 v11, 0xff7fffff
  v_mov_b32 v12, 0
  v_mov_b32 v36, 0
  v_mov_b32 v37, 0
  v_mov_b32 v38, 0
  v_mov_b32 v39, 0
  v_mov_b32 v40, 0
  v_mov_b32 v41, 0
  v_mov_b32 v42, 0
  v_mov_b32 v43, 0
  v_mov_b32 v44, 0
  v_mov_b32 v45, 0
  v_mov_b32 v46, 0
  v_mov_b32 v47, 0
  v_mov_b32 v48, 0
  v_mov_b32 v49, 0
  v_mov_b32 v50, 0
  v_mov_b32 v51, 0
  v_mov_b32 v52, 0
  v_mov_b32 v53, 0
  v_mov_b32 v54, 0
  v_mov_b32 v55, 0
  v_mov_b32 v56, 0
  v_mov_b32 v57, 0
  v_mov_b32 v58, 0
  v_mov_b32 v59, 0
  s_barrier
  v_and_b32 v2, 7, v1
  v_lshlrev_b32 v2, 4, v2
  ds_read_b128 v[24:27], v2 offset:5440
  ds_read_b128 v[28:31], v2 offset:5568
  ds_read_b128 v[32:35], v2 offset:5696
  s_waitcnt lgkmcnt(0)
  s_sub_u32 s56, s91, 4
  s_lshr_b32 s56, s56, 1
S_loop:
  s_waitcnt vmcnt(12)
  v_mov_b32 v13, 0
  v_mov_b32 v14, 0
  v_dot2c_f32_bf16 v13, v60, v24
  v_dot2c_f32_bf16 v14, v72, v24
  v_dot2c_f32_bf16 v13, v61, v25
  v_dot2c_f32_bf16 v14, v73, v25
  v_dot2c_f32_bf16 v13, v62, v26
  v_dot2c_f32_bf16 v14, v74, v26
  v_dot2c_f32_bf16 v13, v63, v27
  v_dot2c_f32_bf16 v14, v75, v27
  v_dot2c_f32_bf16 v13, v64, v28
  v_dot2c_f32_bf16 v14, v76, v28
  v_dot2c_f32_bf16 v13, v65, v29
  v_dot2c_f32_bf16 v14, v77, v29
  v_dot2c_f32_bf16 v13, v66, v30
  v_dot2c_f32_bf16 v14, v78, v30
  v_dot2c_f32_bf16 v13, v67, v31
  v_dot2c_f32_bf16 v14, v79, v31
  v_dot2c_f32_bf16 v13, v68, v32
  v_dot2c_f32_bf16 v14, v80, v32
  v_dot2c_f32_bf16 v13, v69, v33
  v_dot2c_f32_bf16 v14, v81, v33
  v_dot2c_f32_bf16 v13, v70, v34
  v_dot2c_f32_bf16 v14, v82, v34
  v_dot2c_f32_bf16 v13, v71, v35
  v_dot2c_f32_bf16 v14, v83, v35
  s_nop 1
  v_add_f32_dpp v13, v13, v13 quad_perm:[1,0,3,2] row_mask:0xf bank_mask:0xf
  v_add_f32_dpp v14, v14, v14 quad_perm:[1,0,3,2] row_mask:0xf bank_mask:0xf
  s_nop 0
  v_add_f32_dpp v13, v13, v13 quad_perm:[2,3,0,1] row_mask:0xf bank_mask:0xf
  v_add_f32_dpp v14, v14, v14 quad_perm:[2,3,0,1] row_mask:0xf bank_mask:0xf
  s_nop 0
  v_add_f32_dpp v13, v13, v13 row_half_mirror row_mask:0xf bank_mask:0xf
  v_add_f32_dpp v14, v14, v14 row_half_mirror row_mask:0xf bank_mask:0xf
  v_cvt_pk_bf16_f32 v15, v13, v14
  v_lshlrev_b32 v13, 16, v15
  v_and_b32 v14, 0xffff0000, v15
  v_mul_f32 v13, 0x3d93cd3a, v13
  v_mul_f32 v14, 0x3d93cd3a, v14
  v_cvt_pk_bf16_f32 v15, v13, v14
  v_lshlrev_b32 v13, 16, v15
  v_and_b32 v14, 0xffff0000, v15
  v_mul_f32 v13, 0x3fb8aa3b, v13
  v_mul_f32 v14, 0x3fb8aa3b, v14
  v_max3_f32 v16, v11, v13, v14
  s_nop 1
  v_max_f32_dpp v16, v16, v16 row_ror:8 row_mask:0xf bank_mask:0xf
  v_mov_b32 v17, v16
  s_nop 1
  v_permlane16_swap_b32 v16, v17
  v_max_f32 v16, v16, v17
  v_mov_b32 v17, v16
  s_nop 1
  v_permlane32_swap_b32 v16, v17
  v_max_f32 v16, v16, v17
  v_sub_f32 v18, v11, v16
  v_sub_f32 v13, v13, v16
  v_sub_f32 v14, v14, v16
  v_exp_f32 v18, v18
  v_exp_f32 v13, v13
  v_exp_f32 v14, v14
  v_mov_b32 v11, v16
  v_fma_f32 v12, v12, v18, v13
  v_cvt_pk_bf16_f32 v15, v13, v14
  v_add_f32 v12, v12, v14
  v_and_b32 v20, 0xffff, v15
  v_lshlrev_b32 v21, 16, v15
  v_lshrrev_b32 v22, 16, v15
  v_and_b32 v23, 0xffff0000, v15
  v_pk_mul_f32 v[36:37], v[36:37], v[18:19] op_sel_hi:[1,0]
  v_pk_mul_f32 v[38:39], v[38:39], v[18:19] op_sel_hi:[1,0]
  v_pk_mul_f32 v[40:41], v[40:41], v[18:19] op_sel_hi:[1,0]
  v_pk_mul_f32 v[42:43], v[42:43], v[18:19] op_sel_hi:[1,0]
  v_pk_mul_f32 v[44:45], v[44:45], v[18:19] op_sel_hi:[1,0]
  v_pk_mul_f32 v[46:47], v[46:47], v[18:19] op_sel_hi:[1,0]
  v_pk_mul_f32 v[48:49], v[48:49], v[18:19] op_sel_hi:[1,0]
  v_pk_mul_f32 v[50:51], v[50:51], v[18:19] op_sel_hi:[1,0]
  v_pk_mul_f32 v[52:53], v[52:53], v[18:19] op_sel_hi:[1,0]
  v_pk_mul_f32 v[54:55], v[54:55], v[18:19] op_sel_hi:[1,0]
  v_pk_mul_f32 v[56:57], v[56:57], v[18:19] op_sel_hi:[1,0]
  v_pk_mul_f32 v[58:59], v[58:59], v[18:19] op_sel_hi:[1,0]
  v_dot2c_f32_bf16 v36, v84, v20
  v_dot2c_f32_bf16 v37, v84, v21
  v_dot2c_f32_bf16 v38, v85, v20
  v_dot2c_f32_bf16 v39, v85, v21
  v_dot2c_f32_bf16 v40, v86, v20
  v_dot2c_f32_bf16 v41, v86, v21
  v_dot2c_f32_bf16 v42, v87, v20
  v_dot2c_f32_bf16 v43, v87, v21
  v_dot2c_f32_bf16 v44, v88, v20
  v_dot2c_f32_bf16 v45, v88, v21
  v_dot2c_f32_bf16 v46, v89, v20
  v_dot2c_f32_bf16 v47, v89, v21
  v_dot2c_f32_bf16 v48, v90, v20
  v_dot2c_f32_bf16 v49, v90, v21
  v_dot2c_f32_bf16 v50, v91, v20
  v_dot2c_f32_bf16 v51, v91, v21
  v_dot2c_f32_bf16 v52, v92, v20
  v_dot2c_f32_bf16 v53, v92, v21
  v_dot2c_f32_bf16 v54, v93, v20
  v_dot2c_f32_bf16 v55, v93, v21
  v_dot2c_f32_bf16 v56, v94, v20
  v_dot2c_f32_bf16 v57, v94, v21
  v_dot2c_f32_bf16 v58, v95, v20
  v_dot2c_f32_bf16 v59, v95, v21
  v_dot2c_f32_bf16 v36, v96, v22
  v_dot2c_f32_bf16 v37, v96, v23
  v_dot2c_f32_bf16 v38, v97, v22
  v_dot2c_f32_bf16 v39, v97, v23
  v_dot2c_f32_bf16 v40, v98, v22
  v_dot2c_f32_bf16 v41, v98, v23
  v_dot2c_f32_bf16 v42, v99, v22
  v_dot2c_f32_bf16 v43, v99, v23
  v_dot2c_f32_bf16 v44, v100, v22
  v_dot2c_f32_bf16 v45, v100, v23
  v_dot2c_f32_bf16 v46, v101, v22
  v_dot2c_f32_bf16 v47, v101, v23
  v_dot2c_f32_bf16 v48, v102, v22
  v_dot2c_f32_bf16 v49, v102, v23
  v_dot2c_f32_bf16 v50, v103, v22
  v_dot2c_f32_bf16 v51, v103, v23
  v_dot2c_f32_bf16 v52, v104, v22
  v_dot2c_f32_bf16 v53, v104, v23
  v_dot2c_f32_bf16 v54, v105, v22
  v_dot2c_f32_bf16 v55, v105, v23
  v_dot2c_f32_bf16 v56, v106, v22
  v_dot2c_f32_bf16 v57, v106, v23
  v_dot2c_f32_bf16 v58, v107, v22
  v_dot2c_f32_bf16 v59, v107, v23
  s_mul_i32 s54, s53, 6144
  s_add_u32 s54, s54, s52
  buffer_load_dwordx4 v[60:63], v10, s[32:35], s54 offen offset:0 nt
  buffer_load_dwordx4 v[64:67], v10, s[32:35], s54 offen offset:128 nt
  buffer_load_dwordx4 v[68:71], v10, s[32:35], s54 offen offset:256 nt
  buffer_load_dwordx4 v[72:75], v10, s[32:35], s54 offen offset:3072 nt
  buffer_load_dwordx4 v[76:79], v10, s[32:35], s54 offen offset:3200 nt
  buffer_load_dwordx4 v[80:83], v10, s[32:35], s54 offen offset:3328 nt
  buffer_load_dwordx4 v[84:87], v10, s[36:39], s54 offen offset:0 nt
  buffer_load_dwordx4 v[88:91], v10, s[36:39], s54 offen offset:128 nt
  buffer_load_dwordx4 v[92:95], v10, s[36:39], s54 offen offset:256 nt
  buffer_load_dwordx4 v[96:99], v10, s[36:39], s54 offen offset:3072 nt
  buffer_load_dwordx4 v[100:103], v10, s[36:39], s54 offen offset:3200 nt
  buffer_load_dwordx4 v[104:107], v10, s[36:39], s54 offen offset:3328 nt
  s_add_u32 s53, s53, 8
  s_waitcnt vmcnt(12)
  v_mov_b32 v13, 0
  v_mov_b32 v14, 0
  v_dot2c_f32_bf16 v13, v108, v24
  v_dot2c_f32_bf16 v14, v120, v24
  v_dot2c_f32_bf16 v13, v109, v25
  v_dot2c_f32_bf16 v14, v121, v25
  v_dot2c_f32_bf16 v13, v110, v26
  v_dot2c_f32_bf16 v14, v122, v26
  v_dot2c_f32_bf16 v13, v111, v27
  v_dot2c_f32_bf16 v14, v123, v27
  v_dot2c_f32_bf16 v13, v112, v28
  v_dot2c_f32_bf16 v14, v124, v28
  v_dot2c_f32_bf16 v13, v113, v29
  v_dot2c_f32_bf16 v14, v125, v29
  v_dot2c_f32_bf16 v13, v114, v30
  v_dot2c_f32_bf16 v14, v126, v30
  v_dot2c_f32_bf16 v13, v115, v31
  v_dot2c_f32_bf16 v14, v127, v31
  v_dot2c_f32_bf16 v13, v116, v32
  v_dot2c_f32_bf16 v14, v128, v32
  v_dot2c_f32_bf16 v13, v117, v33
  v_dot2c_f32_bf16 v14, v129, v33
  v_dot2c_f32_bf16 v13, v118, v34
  v_dot2c_f32_bf16 v14, v130, v34
  v_dot2c_f32_bf16 v13, v119, v35
  v_dot2c_f32_bf16 v14, v131, v35
  s_nop 1
  v_add_f32_dpp v13, v13, v13 quad_perm:[1,0,3,2] row_mask:0xf bank_mask:0xf
  v_add_f32_dpp v14, v14, v14 quad_perm:[1,0,3,2] row_mask:0xf bank_mask:0xf
  s_nop 0
  v_add_f32_dpp v13, v13, v13 quad_perm:[2,3,0,1] row_mask:0xf bank_mask:0xf
  v_add_f32_dpp v14, v14, v14 quad_perm:[2,3,0,1] row_mask:0xf bank_mask:0xf
  s_nop 0
  v_add_f32_dpp v13, v13, v13 row_half_mirror row_mask:0xf bank_mask:0xf
  v_add_f32_dpp v14, v14, v14 row_half_mirror row_mask:0xf bank_mask:0xf
  v_cvt_pk_bf16_f32 v15, v13, v14
  v_lshlrev_b32 v13, 16, v15
  v_and_b32 v14, 0xffff0000, v15
  v_mul_f32 v13, 0x3d93cd3a, v13
  v_mul_f32 v14, 0x3d93cd3a, v14
  v_cvt_pk_bf16_f32 v15, v13, v14
  v_lshlrev_b32 v13, 16, v15
  v_and_b32 v14, 0xffff0000, v15
  v_mul_f32 v13, 0x3fb8aa3b, v13
  v_mul_f32 v14, 0x3fb8aa3b, v14
  v_max3_f32 v16, v11, v13, v14
  s_nop 1
  v_max_f32_dpp v16, v16, v16 row_ror:8 row_mask:0xf bank_mask:0xf
  v_mov_b32 v17, v16
  s_nop 1
  v_permlane16_swap_b32 v16, v17
  v_max_f32 v16, v16, v17
  v_mov_b32 v17, v16
  s_nop 1
  v_permlane32_swap_b32 v16, v17
  v_max_f32 v16, v16, v17
  v_sub_f32 v18, v11, v16
  v_sub_f32 v13, v13, v16
  v_sub_f32 v14, v14, v16
  v_exp_f32 v18, v18
  v_exp_f32 v13, v13
  v_exp_f32 v14, v14
  v_mov_b32 v11, v16
  v_fma_f32 v12, v12, v18, v13
  v_cvt_pk_bf16_f32 v15, v13, v14
  v_add_f32 v12, v12, v14
  v_and_b32 v20, 0xffff, v15
  v_lshlrev_b32 v21, 16, v15
  v_lshrrev_b32 v22, 16, v15
  v_and_b32 v23, 0xffff0000, v15
  v_pk_mul_f32 v[36:37], v[36:37], v[18:19] op_sel_hi:[1,0]
  v_pk_mul_f32 v[38:39], v[38:39], v[18:19] op_sel_hi:[1,0]
  v_pk_mul_f32 v[40:41], v[40:41], v[18:19] op_sel_hi:[1,0]
  v_pk_mul_f32 v[42:43], v[42:43], v[18:19] op_sel_hi:[1,0]
  v_pk_mul_f32 v[44:45], v[44:45], v[18:19] op_sel_hi:[1,0]
  v_pk_mul_f32 v[46:47], v[46:47], v[18:19] op_sel_hi:[1,0]
  v_pk_mul_f32 v[48:49], v[48:49], v[18:19] op_sel_hi:[1,0]
  v_pk_mul_f32 v[50:51], v[50:51], v[18:19] op_sel_hi:[1,0]
  v_pk_mul_f32 v[52:53], v[52:53], v[18:19] op_sel_hi:[1,0]
  v_pk_mul_f32 v[54:55], v[54:55], v[18:19] op_sel_hi:[1,0]
  v_pk_mul_f32 v[56:57], v[56:57], v[18:19] op_sel_hi:[1,0]
  v_pk_mul_f32 v[58:59], v[58:59], v[18:19] op_sel_hi:[1,0]
  v_dot2c_f32_bf16 v36, v132, v20
  v_dot2c_f32_bf16 v37, v132, v21
  v_dot2c_f32_bf16 v38, v133, v20
  v_dot2c_f32_bf16 v39, v133, v21
  v_dot2c_f32_bf16 v40, v134, v20
  v_dot2c_f32_bf16 v41, v134, v21
  v_dot2c_f32_bf16 v42, v135, v20
  v_dot2c_f32_bf16 v43, v135, v21
  v_dot2c_f32_bf16 v44, v136, v20
  v_dot2c_f32_bf16 v45, v136, v21
  v_dot2c_f32_bf16 v46, v137, v20
  v_dot2c_f32_bf16 v47, v137, v21
  v_dot2c_f32_bf16 v48, v138, v20
  v_dot2c_f32_bf16 v49, v138, v21
  v_dot2c_f32_bf16 v50, v139, v20
  v_dot2c_f32_bf16 v51, v139, v21
  v_dot2c_f32_bf16 v52, v140, v20
  v_dot2c_f32_bf16 v53, v140, v21
  v_dot2c_f32_bf16 v54, v141, v20
  v_dot2c_f32_bf16 v55, v141, v21
  v_dot2c_f32_bf16 v56, v142, v20
  v_dot2c_f32_bf16 v57, v142, v21
  v_dot2c_f32_bf16 v58, v143, v20
  v_dot2c_f32_bf16 v59, v143, v21
  v_dot2c_f32_bf16 v36, v144, v22
  v_dot2c_f32_bf16 v37, v144, v23
  v_dot2c_f32_bf16 v38, v145, v22
  v_dot2c_f32_bf16 v39, v145, v23
  v_dot2c_f32_bf16 v40, v146, v22
  v_dot2c_f32_bf16 v41, v146, v23
  v_dot2c_f32_bf16 v42, v147, v22
  v_dot2c_f32_bf16 v43, v147, v23
  v_dot2c_f32_bf16 v44, v148, v22
  v_dot2c_f32_bf16 v45, v148, v23
  v_dot2c_f32_bf16 v46, v149, v22
  v_dot2c_f32_bf16 v47, v149, v23
  v_dot2c_f32_bf16 v48, v150, v22
  v_dot2c_f32_bf16 v49, v150, v23
  v_dot2c_f32_bf16 v50, v151, v22
  v_dot2c_f32_bf16 v51, v151, v23
  v_dot2c_f32_bf16 v52, v152, v22
  v_dot2c_f32_bf16 v53, v152, v23
  v_dot2c_f32_bf16 v54, v153, v22
  v_dot2c_f32_bf16 v55, v153, v23
  v_dot2c_f32_bf16 v56, v154, v22
  v_dot2c_f32_bf16 v57, v154, v23
  v_dot2c_f32_bf16 v58, v155, v22
  v_dot2c_f32_bf16 v59, v155, v23
  s_mul_i32 s54, s53, 6144
  s_add_u32 s54, s54, s52
  buffer_load_dwordx4 v[108:111], v10, s[32:35], s54 offen offset:0 nt
  buffer_load_dwordx4 v[112:115], v10, s[32:35], s54 offen offset:128 nt
  buffer_load_dwordx4 v[116:119], v10, s[32:35], s54 offen offset:256 nt
  buffer_load_dwordx4 v[120:123], v10, s[32:35], s54 offen offset:3072 nt
  buffer_load_dwordx4 v[124:127], v10, s[32:35], s54 offen offset:3200 nt
  buffer_load_dwordx4 v[128:131], v10, s[32:35], s54 offen offset:3328 nt
  buffer_load_dwordx4 v[132:135], v10, s[36:39], s54 offen offset:0 nt
  buffer_load_dwordx4 v[136:139], v10, s[36:39], s54 offen offset:128 nt
  buffer_load_dwordx4 v[140:143], v10, s[36:39], s54 offen offset:256 nt
  buffer_load_dwordx4 v[144:147], v10, s[36:39], s54 offen offset:3072 nt
  buffer_load_dwordx4 v[148:151], v10, s[36:39], s54 offen offset:3200 nt
  buffer_load_dwordx4 v[152:155], v10, s[36:39], s54 offen offset:3328 nt
  s_add_u32 s53, s53, 8
  s_sub_u32 s56, s56, 1
  s_cmp_lg_u32 s56, 0
  s_cbranch_scc1 S_loop
  s_waitcnt vmcnt(12)
  v_mov_b32 v13, 0
  v_mov_b32 v14, 0
  v_dot2c_f32_bf16 v13, v60, v24
  v_dot2c_f32_bf16 v14, v72, v24
  v_dot2c_f32_bf16 v13, v61, v25
  v_dot2c_f32_bf16 v14, v73, v25
  v_dot2c_f32_bf16 v13, v62, v26
  v_dot2c_f32_bf16 v14, v74, v26
  v_dot2c_f32_bf16 v13, v63, v27
  v_dot2c_f32_bf16 v14, v75, v27
  v_dot2c_f32_bf16 v13, v64, v28
  v_dot2c_f32_bf16 v14, v76, v28
  v_dot2c_f32_bf16 v13, v65, v29
  v_dot2c_f32_bf16 v14, v77, v29
  v_dot2c_f32_bf16 v13, v66, v30
  v_dot2c_f32_bf16 v14, v78, v30
  v_dot2c_f32_bf16 v13, v67, v31
  v_dot2c_f32_bf16 v14, v79, v31
  v_dot2c_f32_bf16 v13, v68, v32
  v_dot2c_f32_bf16 v14, v80, v32
  v_dot2c_f32_bf16 v13, v69, v33
  v_dot2c_f32_bf16 v14, v81, v33
  v_dot2c_f32_bf16 v13, v70, v34
  v_dot2c_f32_bf16 v14, v82, v34
  v_dot2c_f32_bf16 v13, v71, v35
  v_dot2c_f32_bf16 v14, v83, v35
  s_nop 1
  v_add_f32_dpp v13, v13, v13 quad_perm:[1,0,3,2] row_mask:0xf bank_mask:0xf
  v_add_f32_dpp v14, v14, v14 quad_perm:[1,0,3,2] row_mask:0xf bank_mask:0xf
  s_nop 0
  v_add_f32_dpp v13, v13, v13 quad_perm:[2,3,0,1] row_mask:0xf bank_mask:0xf
  v_add_f32_dpp v14, v14, v14 quad_perm:[2,3,0,1] row_mask:0xf bank_mask:0xf
  s_nop 0
  v_add_f32_dpp v13, v13, v13 row_half_mirror row_mask:0xf bank_mask:0xf
  v_add_f32_dpp v14, v14, v14 row_half_mirror row_mask:0xf bank_mask:0xf
  v_cvt_pk_bf16_f32 v15, v13, v14
  v_lshlrev_b32 v13, 16, v15
  v_and_b32 v14, 0xffff0000, v15
  v_mul_f32 v13, 0x3d93cd3a, v13
  v_mul_f32 v14, 0x3d93cd3a, v14
  v_cvt_pk_bf16_f32 v15, v13, v14
  v_lshlrev_b32 v13, 16, v15
  v_and_b32 v14, 0xffff0000, v15
  v_mul_f32 v13, 0x3fb8aa3b, v13
  v_mul_f32 v14, 0x3fb8aa3b, v14
  v_max3_f32 v16, v11, v13, v14
  s_nop 1
  v_max_f32_dpp v16, v16, v16 row_ror:8 row_mask:0xf bank_mask:0xf
  v_mov_b32 v17, v16
  s_nop 1
  v_permlane16_swap_b32 v16, v17
  v_max_f32 v16, v16, v17
  v_mov_b32 v17, v16
  s_nop 1
  v_permlane32_swap_b32 v16, v17
  v_max_f32 v16, v16, v17
  v_sub_f32 v18, v11, v16
  v_sub_f32 v13, v13, v16
  v_sub_f32 v14, v14, v16
  v_exp_f32 v18, v18
  v_exp_f32 v13, v13
  v_exp_f32 v14, v14
  v_mov_b32 v11, v16
  v_fma_f32 v12, v12, v18, v13
  v_cvt_pk_bf16_f32 v15, v13, v14
  v_add_f32 v12, v12, v14
  v_and_b32 v20, 0xffff, v15
  v_lshlrev_b32 v21, 16, v15
  v_lshrrev_b32 v22, 16, v15
  v_and_b32 v23, 0xffff0000, v15
  v_pk_mul_f32 v[36:37], v[36:37], v[18:19] op_sel_hi:[1,0]
  v_pk_mul_f32 v[38:39], v[38:39], v[18:19] op_sel_hi:[1,0]
  v_pk_mul_f32 v[40:41], v[40:41], v[18:19] op_sel_hi:[1,0]
  v_pk_mul_f32 v[42:43], v[42:43], v[18:19] op_sel_hi:[1,0]
  v_pk_mul_f32 v[44:45], v[44:45], v[18:19] op_sel_hi:[1,0]
  v_pk_mul_f32 v[46:47], v[46:47], v[18:19] op_sel_hi:[1,0]
  v_pk_mul_f32 v[48:49], v[48:49], v[18:19] op_sel_hi:[1,0]
  v_pk_mul_f32 v[50:51], v[50:51], v[18:19] op_sel_hi:[1,0]
  v_pk_mul_f32 v[52:53], v[52:53], v[18:19] op_sel_hi:[1,0]
  v_pk_mul_f32 v[54:55], v[54:55], v[18:19] op_sel_hi:[1,0]
  v_pk_mul_f32 v[56:57], v[56:57], v[18:19] op_sel_hi:[1,0]
  v_pk_mul_f32 v[58:59], v[58:59], v[18:19] op_sel_hi:[1,0]
  v_dot2c_f32_bf16 v36, v84, v20
  v_dot2c_f32_bf16 v37, v84, v21
  v_dot2c_f32_bf16 v38, v85, v20
  v_dot2c_f32_bf16 v39, v85, v21
  v_dot2c_f32_bf16 v40, v86, v20
  v_dot2c_f32_bf16 v41, v86, v21
  v_dot2c_f32_bf16 v42, v87, v20
  v_dot2c_f32_bf16 v43, v87, v21
  v_dot2c_f32_bf16 v44, v88, v20
  v_dot2c_f32_bf16 v45, v88, v21
  v_dot2c_f32_bf16 v46, v89, v20
  v_dot2c_f32_bf16 v47, v89, v21
  v_dot2c_f32_bf16 v48, v90, v20
  v_dot2c_f32_bf16 v49, v90, v21
  v_dot2c_f32_bf16 v50, v91, v20
  v_dot2c_f32_bf16 v51, v91, v21
  v_dot2c_f32_bf16 v52, v92, v20
  v_dot2c_f32_bf16 v53, v92, v21
  v_dot2c_f32_bf16 v54, v93, v20
  v_dot2c_f32_bf16 v55, v93, v21
  v_dot2c_f32_bf16 v56, v94, v20
  v_dot2c_f32_bf16 v57, v94, v21
  v_dot2c_f32_bf16 v58, v95, v20
  v_dot2c_f32_bf16 v59, v95, v21
  v_dot2c_f32_bf16 v36, v96, v22
  v_dot2c_f32_bf16 v37, v96, v23
  v_dot2c_f32_bf16 v38, v97, v22
  v_dot2c_f32_bf16 v39, v97, v23
  v_dot2c_f32_bf16 v40, v98, v22
  v_dot2c_f32_bf16 v41, v98, v23
  v_dot2c_f32_bf16 v42, v99, v22
  v_dot2c_f32_bf16 v43, v99, v23
  v_dot2c_f32_bf16 v44, v100, v22
  v_dot2c_f32_bf16 v45, v100, v23
  v_dot2c_f32_bf16 v46, v101, v22
  v_dot2c_f32_bf16 v47, v101, v23
  v_dot2c_f32_bf16 v48, v102, v22
  v_dot2c_f32_bf16 v49, v102, v23
  v_dot2c_f32_bf16 v50, v103, v22
  v_dot2c_f32_bf16 v51, v103, v23
  v_dot2c_f32_bf16 v52, v104, v22
  v_dot2c_f32_bf16 v53, v104, v23
  v_dot2c_f32_bf16 v54, v105, v22
  v_dot2c_f32_bf16 v55, v105, v23
  v_dot2c_f32_bf16 v56, v106, v22
  v_dot2c_f32_bf16 v57, v106, v23
  v_dot2c_f32_bf16 v58, v107, v22
  v_dot2c_f32_bf16 v59, v107, v23
  s_mul_i32 s54, s53, 6144
  s_add_u32 s54, s54, s52
  s_mov_b64 exec, 1
  global_atomic_add v4, v8, v9, s[26:27] sc0
  s_mov_b64 exec, -1
  buffer_load_dwordx4 v[60:63], v10, s[32:35], s54 offen offset:0 nt
  buffer_load_dwordx4 v[64:67], v10, s[32:35], s54 offen offset:128 nt
  buffer_load_dwordx4 v[68:71], v10, s[32:35], s54 offen offset:256 nt
  buffer_load_dwordx4 v[72:75], v10, s[32:35], s54 offen offset:3072 nt
  buffer_load_dwordx4 v[76:79], v10, s[32:35], s54 offen offset:3200 nt
  buffer_load_dwordx4 v[80:83], v10, s[32:35], s54 offen offset:3328 nt
  buffer_load_dwordx4 v[84:87], v10, s[36:39], s54 offen offset:0 nt
  buffer_load_dwordx4 v[88:91], v10, s[36:39], s54 offen offset:128 nt
  buffer_load_dwordx4 v[92:95], v10, s[36:39], s54 offen offset:256 nt
  buffer_load_dwordx4 v[96:99], v10, s[36:39], s54 offen offset:3072 nt
  buffer_load_dwordx4 v[100:103], v10, s[36:39], s54 offen offset:3200 nt
  buffer_load_dwordx4 v[104:107], v10, s[36:39], s54 offen offset:3328 nt
  s_add_u32 s53, s53, 8
  s_waitcnt vmcnt(13)
  v_mov_b32 v13, 0
  v_mov_b32 v14, 0
  v_dot2c_f32_bf16 v13, v108, v24
  v_dot2c_f32_bf16 v14, v120, v24
  v_dot2c_f32_bf16 v13, v109, v25
  v_dot2c_f32_bf16 v14, v121, v25
  v_dot2c_f32_bf16 v13, v110, v26
  v_dot2c_f32_bf16 v14, v122, v26
  v_dot2c_f32_bf16 v13, v111, v27
  v_dot2c_f32_bf16 v14, v123, v27
  v_dot2c_f32_bf16 v13, v112, v28
  v_dot2c_f32_bf16 v14, v124, v28
  v_dot2c_f32_bf16 v13, v113, v29
  v_dot2c_f32_bf16 v14, v125, v29
  v_dot2c_f32_bf16 v13, v114, v30
  v_dot2c_f32_bf16 v14, v126, v30
  v_dot2c_f32_bf16 v13, v115, v31
  v_dot2c_f32_bf16 v14, v127, v31
  v_dot2c_f32_bf16 v13, v116, v32
  v_dot2c_f32_bf16 v14, v128, v32
  v_dot2c_f32_bf16 v13, v117, v33
  v_dot2c_f32_bf16 v14, v129, v33
  v_dot2c_f32_bf16 v13, v118, v34
  v_dot2c_f32_bf16 v14, v130, v34
  v_dot2c_f32_bf16 v13, v119, v35
  v_dot2c_f32_bf16 v14, v131, v35
  s_nop 1
  v_add_f32_dpp v13, v13, v13 quad_perm:[1,0,3,2] row_mask:0xf bank_mask:0xf
  v_add_f32_dpp v14, v14, v14 quad_perm:[1,0,3,2] row_mask:0xf bank_mask:0xf
  s_nop 0
  v_add_f32_dpp v13, v13, v13 quad_perm:[2,3,0,1] row_mask:0xf bank_mask:0xf
  v_add_f32_dpp v14, v14, v14 quad_perm:[2,3,0,1] row_mask:0xf bank_mask:0xf
  s_nop 0
  v_add_f32_dpp v13, v13, v13 row_half_mirror row_mask:0xf bank_mask:0xf
  v_add_f32_dpp v14, v14, v14 row_half_mirror row_mask:0xf bank_mask:0xf
  v_cvt_pk_bf16_f32 v15, v13, v14
  v_lshlrev_b32 v13, 16, v15
  v_and_b32 v14, 0xffff0000, v15
  v_mul_f32 v13, 0x3d93cd3a, v13
  v_mul_f32 v14, 0x3d93cd3a, v14
  v_cvt_pk_bf16_f32 v15, v13, v14
  v_lshlrev_b32 v13, 16, v15
  v_and_b32 v14, 0xffff0000, v15
  v_mul_f32 v13, 0x3fb8aa3b, v13
  v_mul_f32 v14, 0x3fb8aa3b, v14
  v_max3_f32 v16, v11, v13, v14
  s_nop 1
  v_max_f32_dpp v16, v16, v16 row_ror:8 row_mask:0xf bank_mask:0xf
  v_mov_b32 v17, v16
  s_nop 1
  v_permlane16_swap_b32 v16, v17
  v_max_f32 v16, v16, v17
  v_mov_b32 v17, v16
  s_nop 1
  v_permlane32_swap_b32 v16, v17
  v_max_f32 v16, v16, v17
  v_sub_f32 v18, v11, v16
  v_sub_f32 v13, v13, v16
  v_sub_f32 v14, v14, v16
  v_exp_f32 v18, v18
  v_exp_f32 v13, v13
  v_exp_f32 v14, v14
  v_mov_b32 v11, v16
  v_fma_f32 v12, v12, v18, v13
  v_cvt_pk_bf16_f32 v15, v13, v14
  v_add_f32 v12, v12, v14
  v_and_b32 v20, 0xffff, v15
  v_lshlrev_b32 v21, 16, v15
  v_lshrrev_b32 v22, 16, v15
  v_and_b32 v23, 0xffff0000, v15
  v_pk_mul_f32 v[36:37], v[36:37], v[18:19] op_sel_hi:[1,0]
  v_pk_mul_f32 v[38:39], v[38:39], v[18:19] op_sel_hi:[1,0]
  v_pk_mul_f32 v[40:41], v[40:41], v[18:19] op_sel_hi:[1,0]
  v_pk_mul_f32 v[42:43], v[42:43], v[18:19] op_sel_hi:[1,0]
  v_pk_mul_f32 v[44:45], v[44:45], v[18:19] op_sel_hi:[1,0]
  v_pk_mul_f32 v[46:47], v[46:47], v[18:19] op_sel_hi:[1,0]
  v_pk_mul_f32 v[48:49], v[48:49], v[18:19] op_sel_hi:[1,0]
  v_pk_mul_f32 v[50:51], v[50:51], v[18:19] op_sel_hi:[1,0]
  v_pk_mul_f32 v[52:53], v[52:53], v[18:19] op_sel_hi:[1,0]
  v_pk_mul_f32 v[54:55], v[54:55], v[18:19] op_sel_hi:[1,0]
  v_pk_mul_f32 v[56:57], v[56:57], v[18:19] op_sel_hi:[1,0]
  v_pk_mul_f32 v[58:59], v[58:59], v[18:19] op_sel_hi:[1,0]
  v_dot2c_f32_bf16 v36, v132, v20
  v_dot2c_f32_bf16 v37, v132, v21
  v_dot2c_f32_bf16 v38, v133, v20
  v_dot2c_f32_bf16 v39, v133, v21
  v_dot2c_f32_bf16 v40, v134, v20
  v_dot2c_f32_bf16 v41, v134, v21
  v_dot2c_f32_bf16 v42, v135, v20
  v_dot2c_f32_bf16 v43, v135, v21
  v_dot2c_f32_bf16 v44, v136, v20
  v_dot2c_f32_bf16 v45, v136, v21
  v_dot2c_f32_bf16 v46, v137, v20
  v_dot2c_f32_bf16 v47, v137, v21
  v_dot2c_f32_bf16 v48, v138, v20
  v_dot2c_f32_bf16 v49, v138, v21
  v_dot2c_f32_bf16 v50, v139, v20
  v_dot2c_f32_bf16 v51, v139, v21
  v_dot2c_f32_bf16 v52, v140, v20
  v_dot2c_f32_bf16 v53, v140, v21
  v_dot2c_f32_bf16 v54, v141, v20
  v_dot2c_f32_bf16 v55, v141, v21
  v_dot2c_f32_bf16 v56, v142, v20
  v_dot2c_f32_bf16 v57, v142, v21
  v_dot2c_f32_bf16 v58, v143, v20
  v_dot2c_f32_bf16 v59, v143, v21
  v_dot2c_f32_bf16 v36, v144, v22
  v_dot2c_f32_bf16 v37, v144, v23
  v_dot2c_f32_bf16 v38, v145, v22
  v_dot2c_f32_bf16 v39, v145, v23
  v_dot2c_f32_bf16 v40, v146, v22
  v_dot2c_f32_bf16 v41, v146, v23
  v_dot2c_f32_bf16 v42, v147, v22
  v_dot2c_f32_bf16 v43, v147, v23
  v_dot2c_f32_bf16 v44, v148, v22
  v_dot2c_f32_bf16 v45, v148, v23
  v_dot2c_f32_bf16 v46, v149, v22
  v_dot2c_f32_bf16 v47, v149, v23
  v_dot2c_f32_bf16 v48, v150, v22
  v_dot2c_f32_bf16 v49, v150, v23
  v_dot2c_f32_bf16 v50, v151, v22
  v_dot2c_f32_bf16 v51, v151, v23
  v_dot2c_f32_bf16 v52, v152, v22
  v_dot2c_f32_bf16 v53, v152, v23
  v_dot2c_f32_bf16 v54, v153, v22
  v_dot2c_f32_bf16 v55, v153, v23
  v_dot2c_f32_bf16 v56, v154, v22
  v_dot2c_f32_bf16 v57, v154, v23
  v_dot2c_f32_bf16 v58, v155, v22
  v_dot2c_f32_bf16 v59, v155, v23
  s_mul_i32 s54, s53, 6144
  s_add_u32 s54, s54, s52
  s_mov_b64 exec, 1
  global_atomic_add v5, v8, v9, s[26:27] sc0
  s_mov_b64 exec, -1
  buffer_load_dwordx4 v[108:111], v10, s[32:35], s54 offen offset:0 nt
  buffer_load_dwordx4 v[112:115], v10, s[32:35], s54 offen offset:128 nt
  buffer_load_dwordx4 v[116:119], v10, s[32:35], s54 offen offset:256 nt
  buffer_load_dwordx4 v[120:123], v10, s[32:35], s54 offen offset:3072 nt
  buffer_load_dwordx4 v[124:127], v10, s[32:35], s54 offen offset:3200 nt
  buffer_load_dwordx4 v[128:131], v10, s[32:35], s54 offen offset:3328 nt
  buffer_load_dwordx4 v[132:135], v10, s[36:39], s54 offen offset:0 nt
  buffer_load_dwordx4 v[136:139], v10, s[36:39], s54 offen offset:128 nt
  buffer_load_dwordx4 v[140:143], v10, s[36:39], s54 offen offset:256 nt
  buffer_load_dwordx4 v[144:147], v10, s[36:39], s54 offen offset:3072 nt
  buffer_load_dwordx4 v[148:151], v10, s[36:39], s54 offen offset:3200 nt
  buffer_load_dwordx4 v[152:155], v10, s[36:39], s54 offen offset:3328 nt
  s_add_u32 s53, s53, 8
S_dyn:
  s_waitcnt vmcnt(13)
  v_mov_b32 v13, 0
  v_mov_b32 v14, 0
  v_dot2c_f32_bf16 v13, v60, v24
  v_dot2c_f32_bf16 v14, v72, v24
  v_dot2c_f32_bf16 v13, v61, v25
  v_dot2c_f32_bf16 v14, v73, v25
  v_dot2c_f32_bf16 v13, v62, v26
  v_dot2c_f32_bf16 v14, v74, v26
  v_dot2c_f32_bf16 v13, v63, v27
  v_dot2c_f32_bf16 v14, v75, v27
  v_dot2c_f32_bf16 v13, v64, v28
  v_dot2c_f32_bf16 v14, v76, v28
  v_dot2c_f32_bf16 v13, v65, v29
  v_dot2c_f32_bf16 v14, v77, v29
  v_dot2c_f32_bf16 v13, v66, v30
  v_dot2c_f32_bf16 v14, v78, v30
  v_dot2c_f32_bf16 v13, v67, v31
  v_dot2c_f32_bf16 v14, v79, v31
  v_dot2c_f32_bf16 v13, v68, v32
  v_dot2c_f32_bf16 v14, v80, v32
  v_dot2c_f32_bf16 v13, v69, v33
  v_dot2c_f32_bf16 v14, v81, v33
  v_dot2c_f32_bf16 v13, v70, v34
  v_dot2c_f32_bf16 v14, v82, v34
  v_dot2c_f32_bf16 v13, v71, v35
  v_dot2c_f32_bf16 v14, v83, v35
  s_nop 1
  v_add_f32_dpp v13, v13, v13 quad_perm:[1,0,3,2] row_mask:0xf bank_mask:0xf
  v_add_f32_dpp v14, v14, v14 quad_perm:[1,0,3,2] row_mask:0xf bank_mask:0xf
  s_nop 0
  v_add_f32_dpp v13, v13, v13 quad_perm:[2,3,0,1] row_mask:0xf bank_mask:0xf
  v_add_f32_dpp v14, v14, v14 quad_perm:[2,3,0,1] row_mask:0xf bank_mask:0xf
  s_nop 0
  v_add_f32_dpp v13, v13, v13 row_half_mirror row_mask:0xf bank_mask:0xf
  v_add_f32_dpp v14, v14, v14 row_half_mirror row_mask:0xf bank_mask:0xf
  v_cvt_pk_bf16_f32 v15, v13, v14
  v_lshlrev_b32 v13, 16, v15
  v_and_b32 v14, 0xffff0000, v15
  v_mul_f32 v13, 0x3d93cd3a, v13
  v_mul_f32 v14, 0x3d93cd3a, v14
  v_cvt_pk_bf16_f32 v15, v13, v14
  v_lshlrev_b32 v13, 16, v15
  v_and_b32 v14, 0xffff0000, v15
  v_mul_f32 v13, 0x3fb8aa3b, v13
  v_mul_f32 v14, 0x3fb8aa3b, v14
  v_max3_f32 v16, v11, v13, v14
  s_nop 1
  v_max_f32_dpp v16, v16, v16 row_ror:8 row_mask:0xf bank_mask:0xf
  v_mov_b32 v17, v16
  s_nop 1
  v_permlane16_swap_b32 v16, v17
  v_max_f32 v16, v16, v17
  v_mov_b32 v17, v16
  s_nop 1
  v_permlane32_swap_b32 v16, v17
  v_max_f32 v16, v16, v17
  v_sub_f32 v18, v11, v16
  v_sub_f32 v13, v13, v16
  v_sub_f32 v14, v14, v16
  v_exp_f32 v18, v18
  v_exp_f32 v13, v13
  v_exp_f32 v14, v14
  v_mov_b32 v11, v16
  v_fma_f32 v12, v12, v18, v13
  v_cvt_pk_bf16_f32 v15, v13, v14
  v_add_f32 v12, v12, v14
  v_and_b32 v20, 0xffff, v15
  v_lshlrev_b32 v21, 16, v15
  v_lshrrev_b32 v22, 16, v15
  v_and_b32 v23, 0xffff0000, v15
  v_pk_mul_f32 v[36:37], v[36:37], v[18:19] op_sel_hi:[1,0]
  v_pk_mul_f32 v[38:39], v[38:39], v[18:19] op_sel_hi:[1,0]
  v_pk_mul_f32 v[40:41], v[40:41], v[18:19] op_sel_hi:[1,0]
  v_pk_mul_f32 v[42:43], v[42:43], v[18:19] op_sel_hi:[1,0]
  v_pk_mul_f32 v[44:45], v[44:45], v[18:19] op_sel_hi:[1,0]
  v_pk_mul_f32 v[46:47], v[46:47], v[18:19] op_sel_hi:[1,0]
  v_pk_mul_f32 v[48:49], v[48:49], v[18:19] op_sel_hi:[1,0]
  v_pk_mul_f32 v[50:51], v[50:51], v[18:19] op_sel_hi:[1,0]
  v_pk_mul_f32 v[52:53], v[52:53], v[18:19] op_sel_hi:[1,0]
  v_pk_mul_f32 v[54:55], v[54:55], v[18:19] op_sel_hi:[1,0]
  v_pk_mul_f32 v[56:57], v[56:57], v[18:19] op_sel_hi:[1,0]
  v_pk_mul_f32 v[58:59], v[58:59], v[18:19] op_sel_hi:[1,0]
  v_dot2c_f32_bf16 v36, v84, v20
  v_dot2c_f32_bf16 v37, v84, v21
  v_dot2c_f32_bf16 v38, v85, v20
  v_dot2c_f32_bf16 v39, v85, v21
  v_dot2c_f32_bf16 v40, v86, v20
  v_dot2c_f32_bf16 v41, v86, v21
  v_dot2c_f32_bf16 v42, v87, v20
  v_dot2c_f32_bf16 v43, v87, v21
  v_dot2c_f32_bf16 v44, v88, v20
  v_dot2c_f32_bf16 v45, v88, v21
  v_dot2c_f32_bf16 v46, v89, v20
  v_dot2c_f32_bf16 v47, v89, v21
  v_dot2c_f32_bf16 v48, v90, v20
  v_dot2c_f32_bf16 v49, v90, v21
  v_dot2c_f32_bf16 v50, v91, v20
  v_dot2c_f32_bf16 v51, v91, v21
  v_dot2c_f32_bf16 v52, v92, v20
  v_dot2c_f32_bf16 v53, v92, v21
  v_dot2c_f32_bf16 v54, v93, v20
  v_dot2c_f32_bf16 v55, v93, v21
  v_dot2c_f32_bf16 v56, v94, v20
  v_dot2c_f32_bf16 v57, v94, v21
  v_dot2c_f32_bf16 v58, v95, v20
  v_dot2c_f32_bf16 v59, v95, v21
  v_dot2c_f32_bf16 v36, v96, v22
  v_dot2c_f32_bf16 v37, v96, v23
  v_dot2c_f32_bf16 v38, v97, v22
  v_dot2c_f32_bf16 v39, v97, v23
  v_dot2c_f32_bf16 v40, v98, v22
  v_dot2c_f32_bf16 v41, v98, v23
  v_dot2c_f32_bf16 v42, v99, v22
  v_dot2c_f32_bf16 v43, v99, v23
  v_dot2c_f32_bf16 v44, v100, v22
  v_dot2c_f32_bf16 v45, v100, v23
  v_dot2c_f32_bf16 v46, v101, v22
  v_dot2c_f32_bf16 v47, v101, v23
  v_dot2c_f32_bf16 v48, v102, v22
  v_dot2c_f32_bf16 v49, v102, v23
  v_dot2c_f32_bf16 v50, v103, v22
  v_dot2c_f32_bf16 v51, v103, v23
  v_dot2c_f32_bf16 v52, v104, v22
  v_dot2c_f32_bf16 v53, v104, v23
  v_dot2c_f32_bf16 v54, v105, v22
  v_dot2c_f32_bf16 v55, v105, v23
  v_dot2c_f32_bf16 v56, v106, v22
  v_dot2c_f32_bf16 v57, v106, v23
  v_dot2c_f32_bf16 v58, v107, v22
  v_dot2c_f32_bf16 v59, v107, v23
  v_readfirstlane_b32 s53, v4
  s_nop 0
  s_add_u32 s53, s53, s92
  s_cmp_ge_u32 s53, 256
  s_cbranch_scc1 S_drain0
  s_mul_i32 s54, s53, 6144
  s_add_u32 s54, s54, s52
  s_mov_b64 exec, 1
  global_atomic_add v4, v8, v9, s[26:27] sc0
  s_mov_b64 exec, -1
  buffer_load_dwordx4 v[60:63], v10, s[32:35], s54 offen offset:0 nt
  buffer_load_dwordx4 v[64:67], v10, s[32:35], s54 offen offset:128 nt
  buffer_load_dwordx4 v[68:71], v10, s[32:35], s54 offen offset:256 nt
  buffer_load_dwordx4 v[72:75], v10, s[32:35], s54 offen offset:3072 nt
  buffer_load_dwordx4 v[76:79], v10, s[32:35], s54 offen offset:3200 nt
  buffer_load_dwordx4 v[80:83], v10, s[32:35], s54 offen offset:3328 nt
  buffer_load_dwordx4 v[84:87], v10, s[36:39], s54 offen offset:0 nt
  buffer_load_dwordx4 v[88:91], v10, s[36:39], s54 offen offset:128 nt
  buffer_load_dwordx4 v[92:95], v10, s[36:39], s54 offen offset:256 nt
  buffer_load_dwordx4 v[96:99], v10, s[36:39], s54 offen offset:3072 nt
  buffer_load_dwordx4 v[100:103], v10, s[36:39], s54 offen offset:3200 nt
  buffer_load_dwordx4 v[104:107], v10, s[36:39], s54 offen offset:3328 nt
  s_waitcnt vmcnt(13)
  v_mov_b32 v13, 0
  v_mov_b32 v14, 0
  v_dot2c_f32_bf16 v13, v108, v24
  v_dot2c_f32_bf16 v14, v120, v24
  v_dot2c_f32_bf16 v13, v109, v25
  v_dot2c_f32_bf16 v14, v121, v25
  v_dot2c_f32_bf16 v13, v110, v26
  v_dot2c_f32_bf16 v14, v122, v26
  v_dot2c_f32_bf16 v13, v111, v27
  v_dot2c_f32_bf16 v14, v123, v27
  v_dot2c_f32_bf16 v13, v112, v28
  v_dot2c_f32_bf16 v14, v124, v28
  v_dot2c_f32_bf16 v13, v113, v29
  v_dot2c_f32_bf16 v14, v125, v29
  v_dot2c_f32_bf16 v13, v114, v30
  v_dot2c_f32_bf16 v14, v126, v30
  v_dot2c_f32_bf16 v13, v115, v31
  v_dot2c_f32_bf16 v14, v127, v31
  v_dot2c_f32_bf16 v13, v116, v32
  v_dot2c_f32_bf16 v14, v128, v32
  v_dot2c_f32_bf16 v13, v117, v33
  v_dot2c_f32_bf16 v14, v129, v33
  v_dot2c_f32_bf16 v13, v118, v34
  v_dot2c_f32_bf16 v14, v130, v34
  v_dot2c_f32_bf16 v13, v119, v35
  v_dot2c_f32_bf16 v14, v131, v35
  s_nop 1
  v_add_f32_dpp v13, v13, v13 quad_perm:[1,0,3,2] row_mask:0xf bank_mask:0xf
  v_add_f32_dpp v14, v14, v14 quad_perm:[1,0,3,2] row_mask:0xf bank_mask:0xf
  s_nop 0
  v_add_f32_dpp v13, v13, v13 quad_perm:[2,3,0,1] row_mask:0xf bank_mask:0xf
  v_add_f32_dpp v14, v14, v14 quad_perm:[2,3,0,1] row_mask:0xf bank_mask:0xf
  s_nop 0
  v_add_f32_dpp v13, v13, v13 row_half_mirror row_mask:0xf bank_mask:0xf
  v_add_f32_dpp v14, v14, v14 row_half_mirror row_mask:0xf bank_mask:0xf
  v_cvt_pk_bf16_f32 v15, v13, v14
  v_lshlrev_b32 v13, 16, v15
  v_and_b32 v14, 0xffff0000, v15
  v_mul_f32 v13, 0x3d93cd3a, v13
  v_mul_f32 v14, 0x3d93cd3a, v14
  v_cvt_pk_bf16_f32 v15, v13, v14
  v_lshlrev_b32 v13, 16, v15
  v_and_b32 v14, 0xffff0000, v15
  v_mul_f32 v13, 0x3fb8aa3b, v13
  v_mul_f32 v14, 0x3fb8aa3b, v14
  v_max3_f32 v16, v11, v13, v14
  s_nop 1
  v_max_f32_dpp v16, v16, v16 row_ror:8 row_mask:0xf bank_mask:0xf
  v_mov_b32 v17, v16
  s_nop 1
  v_permlane16_swap_b32 v16, v17
  v_max_f32 v16, v16, v17
  v_mov_b32 v17, v16
  s_nop 1
  v_permlane32_swap_b32 v16, v17
  v_max_f32 v16, v16, v17
  v_sub_f32 v18, v11, v16
  v_sub_f32 v13, v13, v16
  v_sub_f32 v14, v14, v16
  v_exp_f32 v18, v18
  v_exp_f32 v13, v13
  v_exp_f32 v14, v14
  v_mov_b32 v11, v16
  v_fma_f32 v12, v12, v18, v13
  v_cvt_pk_bf16_f32 v15, v13, v14
  v_add_f32 v12, v12, v14
  v_and_b32 v20, 0xffff, v15
  v_lshlrev_b32 v21, 16, v15
  v_lshrrev_b32 v22, 16, v15
  v_and_b32 v23, 0xffff0000, v15
  v_pk_mul_f32 v[36:37], v[36:37], v[18:19] op_sel_hi:[1,0]
  v_pk_mul_f32 v[38:39], v[38:39], v[18:19] op_sel_hi:[1,0]
  v_pk_mul_f32 v[40:41], v[40:41], v[18:19] op_sel_hi:[1,0]
  v_pk_mul_f32 v[42:43], v[42:43], v[18:19] op_sel_hi:[1,0]
  v_pk_mul_f32 v[44:45], v[44:45], v[18:19] op_sel_hi:[1,0]
  v_pk_mul_f32 v[46:47], v[46:47], v[18:19] op_sel_hi:[1,0]
  v_pk_mul_f32 v[48:49], v[48:49], v[18:19] op_sel_hi:[1,0]
  v_pk_mul_f32 v[50:51], v[50:51], v[18:19] op_sel_hi:[1,0]
  v_pk_mul_f32 v[52:53], v[52:53], v[18:19] op_sel_hi:[1,0]
  v_pk_mul_f32 v[54:55], v[54:55], v[18:19] op_sel_hi:[1,0]
  v_pk_mul_f32 v[56:57], v[56:57], v[18:19] op_sel_hi:[1,0]
  v_pk_mul_f32 v[58:59], v[58:59], v[18:19] op_sel_hi:[1,0]
  v_dot2c_f32_bf16 v36, v132, v20
  v_dot2c_f32_bf16 v37, v132, v21
  v_dot2c_f32_bf16 v38, v133, v20
  v_dot2c_f32_bf16 v39, v133, v21
  v_dot2c_f32_bf16 v40, v134, v20
  v_dot2c_f32_bf16 v41, v134, v21
  v_dot2c_f32_bf16 v42, v135, v20
  v_dot2c_f32_bf16 v43, v135, v21
  v_dot2c_f32_bf16 v44, v136, v20
  v_dot2c_f32_bf16 v45, v136, v21
  v_dot2c_f32_bf16 v46, v137, v20
  v_dot2c_f32_bf16 v47, v137, v21
  v_dot2c_f32_bf16 v48, v138, v20
  v_dot2c_f32_bf16 v49, v138, v21
  v_dot2c_f32_bf16 v50, v139, v20
  v_dot2c_f32_bf16 v51, v139, v21
  v_dot2c_f32_bf16 v52, v140, v20
  v_dot2c_f32_bf16 v53, v140, v21
  v_dot2c_f32_bf16 v54, v141, v20
  v_dot2c_f32_bf16 v55, v141, v21
  v_dot2c_f32_bf16 v56, v142, v20
  v_dot2c_f32_bf16 v57, v142, v21
  v_dot2c_f32_bf16 v58, v143, v20
  v_dot2c_f32_bf16 v59, v143, v21
  v_dot2c_f32_bf16 v36, v144, v22
  v_dot2c_f32_bf16 v37, v144, v23
  v_dot2c_f32_bf16 v38, v145, v22
  v_dot2c_f32_bf16 v39, v145, v23
  v_dot2c_f32_bf16 v40, v146, v22
  v_dot2c_f32_bf16 v41, v146, v23
  v_dot2c_f32_bf16 v42, v147, v22
  v_dot2c_f32_bf16 v43, v147, v23
  v_dot2c_f32_bf16 v44, v148, v22
  v_dot2c_f32_bf16 v45, v148, v23
  v_dot2c_f32_bf16 v46, v149, v22
  v_dot2c_f32_bf16 v47, v149, v23
  v_dot2c_f32_bf16 v48, v150, v22
  v_dot2c_f32_bf16 v49, v150, v23
  v_dot2c_f32_bf16 v50, v151, v22
  v_dot2c_f32_bf16 v51, v151, v23
  v_dot2c_f32_bf16 v52, v152, v22
  v_dot2c_f32_bf16 v53, v152, v23
  v_dot2c_f32_bf16 v54, v153, v22
  v_dot2c_f32_bf16 v55, v153, v23
  v_dot2c_f32_bf16 v56, v154, v22
  v_dot2c_f32_bf16 v57, v154, v23
  v_dot2c_f32_bf16 v58, v155, v22
  v_dot2c_f32_bf16 v59, v155, v23
  v_readfirstlane_b32 s53, v5
  s_nop 0
  s_add_u32 s53, s53, s92
  s_cmp_ge_u32 s53, 256
  s_cbranch_scc1 S_drain1
  s_mul_i32 s54, s53, 6144
  s_add_u32 s54, s54, s52
  s_mov_b64 exec, 1
  global_atomic_add v5, v8, v9, s[26:27] sc0
  s_mov_b64 exec, -1
  buffer_load_dwordx4 v[108:111], v10, s[32:35], s54 offen offset:0 nt
  buffer_load_dwordx4 v[112:115], v10, s[32:35], s54 offen offset:128 nt
  buffer_load_dwordx4 v[116:119], v10, s[32:35], s54 offen offset:256 nt
  buffer_load_dwordx4 v[120:123], v10, s[32:35], s54 offen offset:3072 nt
  buffer_load_dwordx4 v[124:127], v10, s[32:35], s54 offen offset:3200 nt
  buffer_load_dwordx4 v[128:131], v10, s[32:35], s54 offen offset:3328 nt
  buffer_load_dwordx4 v[132:135], v10, s[36:39], s54 offen offset:0 nt
  buffer_load_dwordx4 v[136:139], v10, s[36:39], s54 offen offset:128 nt
  buffer_load_dwordx4 v[140:143], v10, s[36:39], s54 offen offset:256 nt
  buffer_load_dwordx4 v[144:147], v10, s[36:39], s54 offen offset:3072 nt
  buffer_load_dwordx4 v[148:151], v10, s[36:39], s54 offen offset:3200 nt
  buffer_load_dwordx4 v[152:155], v10, s[36:39], s54 offen offset:3328 nt
  s_branch S_dyn
S_drain0:
  s_waitcnt vmcnt(0)
  v_mov_b32 v13, 0
  v_mov_b32 v14, 0
  v_dot2c_f32_bf16 v13, v108, v24
  v_dot2c_f32_bf16 v14, v120, v24
  v_dot2c_f32_bf16 v13, v109, v25
  v_dot2c_f32_bf16 v14, v121, v25
  v_dot2c_f32_bf16 v13, v110, v26
  v_dot2c_f32_bf16 v14, v122, v26
  v_dot2c_f32_bf16 v13, v111, v27
  v_dot2c_f32_bf16 v14, v123, v27
  v_dot2c_f32_bf16 v13, v112, v28
  v_dot2c_f32_bf16 v14, v124, v28
  v_dot2c_f32_bf16 v13, v113, v29
  v_dot2c_f32_bf16 v14, v125, v29
  v_dot2c_f32_bf16 v13, v114, v30
  v_dot2c_f32_bf16 v14, v126, v30
  v_dot2c_f32_bf16 v13, v115, v31
  v_dot2c_f32_bf16 v14, v127, v31
  v_dot2c_f32_bf16 v13, v116, v32
  v_dot2c_f32_bf16 v14, v128, v32
  v_dot2c_f32_bf16 v13, v117, v33
  v_dot2c_f32_bf16 v14, v129, v33
  v_dot2c_f32_bf16 v13, v118, v34
  v_dot2c_f32_bf16 v14, v130, v34
  v_dot2c_f32_bf16 v13, v119, v35
  v_dot2c_f32_bf16 v14, v131, v35
  s_nop 1
  v_add_f32_dpp v13, v13, v13 quad_perm:[1,0,3,2] row_mask:0xf bank_mask:0xf
  v_add_f32_dpp v14, v14, v14 quad_perm:[1,0,3,2] row_mask:0xf bank_mask:0xf
  s_nop 0
  v_add_f32_dpp v13, v13, v13 quad_perm:[2,3,0,1] row_mask:0xf bank_mask:0xf
  v_add_f32_dpp v14, v14, v14 quad_perm:[2,3,0,1] row_mask:0xf bank_mask:0xf
  s_nop 0
  v_add_f32_dpp v13, v13, v13 row_half_mirror row_mask:0xf bank_mask:0xf
  v_add_f32_dpp v14, v14, v14 row_half_mirror row_mask:0xf bank_mask:0xf
  v_cvt_pk_bf16_f32 v15, v13, v14
  v_lshlrev_b32 v13, 16, v15
  v_and_b32 v14, 0xffff0000, v15
  v_mul_f32 v13, 0x3d93cd3a, v13
  v_mul_f32 v14, 0x3d93cd3a, v14
  v_cvt_pk_bf16_f32 v15, v13, v14
  v_lshlrev_b32 v13, 16, v15
  v_and_b32 v14, 0xffff0000, v15
  v_mul_f32 v13, 0x3fb8aa3b, v13
  v_mul_f32 v14, 0x3fb8aa3b, v14
  v_max3_f32 v16, v11, v13, v14
  s_nop 1
  v_max_f32_dpp v16, v16, v16 row_ror:8 row_mask:0xf bank_mask:0xf
  v_mov_b32 v17, v16
  s_nop 1
  v_permlane16_swap_b32 v16, v17
  v_max_f32 v16, v16, v17
  v_mov_b32 v17, v16
  s_nop 1
  v_permlane32_swap_b32 v16, v17
  v_max_f32 v16, v16, v17
  v_sub_f32 v18, v11, v16
  v_sub_f32 v13, v13, v16
  v_sub_f32 v14, v14, v16
  v_exp_f32 v18, v18
  v_exp_f32 v13, v13
  v_exp_f32 v14, v14
  v_mov_b32 v11, v16
  v_fma_f32 v12, v12, v18, v13
  v_cvt_pk_bf16_f32 v15, v13, v14
  v_add_f32 v12, v12, v14
  v_and_b32 v20, 0xffff, v15
  v_lshlrev_b32 v21, 16, v15
  v_lshrrev_b32 v22, 16, v15
  v_and_b32 v23, 0xffff0000, v15
  v_pk_mul_f32 v[36:37], v[36:37], v[18:19] op_sel_hi:[1,0]
  v_pk_mul_f32 v[38:39], v[38:39], v[18:19] op_sel_hi:[1,0]
  v_pk_mul_f32 v[40:41], v[40:41], v[18:19] op_sel_hi:[1,0]
  v_pk_mul_f32 v[42:43], v[42:43], v[18:19] op_sel_hi:[1,0]
  v_pk_mul_f32 v[44:45], v[44:45], v[18:19] op_sel_hi:[1,0]
  v_pk_mul_f32 v[46:47], v[46:47], v[18:19] op_sel_hi:[1,0]
  v_pk_mul_f32 v[48:49], v[48:49], v[18:19] op_sel_hi:[1,0]
  v_pk_mul_f32 v[50:51], v[50:51], v[18:19] op_sel_hi:[1,0]
  v_pk_mul_f32 v[52:53], v[52:53], v[18:19] op_sel_hi:[1,0]
  v_pk_mul_f32 v[54:55], v[54:55], v[18:19] op_sel_hi:[1,0]
  v_pk_mul_f32 v[56:57], v[56:57], v[18:19] op_sel_hi:[1,0]
  v_pk_mul_f32 v[58:59], v[58:59], v[18:19] op_sel_hi:[1,0]
  v_dot2c_f32_bf16 v36, v132, v20
  v_dot2c_f32_bf16 v37, v132, v21
  v_dot2c_f32_bf16 v38, v133, v20
  v_dot2c_f32_bf16 v39, v133, v21
  v_dot2c_f32_bf16 v40, v134, v20
  v_dot2c_f32_bf16 v41, v134, v21
  v_dot2c_f32_bf16 v42, v135, v20
  v_dot2c_f32_bf16 v43, v135, v21
  v_dot2c_f32_bf16 v44, v136, v20
  v_dot2c_f32_bf16 v45, v136, v21
  v_dot2c_f32_bf16 v46, v137, v20
  v_dot2c_f32_bf16 v47, v137, v21
  v_dot2c_f32_bf16 v48, v138, v20
  v_dot2c_f32_bf16 v49, v138, v21
  v_dot2c_f32_bf16 v50, v139, v20
  v_dot2c_f32_bf16 v51, v139, v21
  v_dot2c_f32_bf16 v52, v140, v20
  v_dot2c_f32_bf16 v53, v140, v21
  v_dot2c_f32_bf16 v54, v141, v20
  v_dot2c_f32_bf16 v55, v141, v21
  v_dot2c_f32_bf16 v56, v142, v20
  v_dot2c_f32_bf16 v57, v142, v21
  v_dot2c_f32_bf16 v58, v143, v20
  v_dot2c_f32_bf16 v59, v143, v21
  v_dot2c_f32_bf16 v36, v144, v22
  v_dot2c_f32_bf16 v37, v144, v23
  v_dot2c_f32_bf16 v38, v145, v22
  v_dot2c_f32_bf16 v39, v145, v23
  v_dot2c_f32_bf16 v40, v146, v22
  v_dot2c_f32_bf16 v41, v146, v23
  v_dot2c_f32_bf16 v42, v147, v22
  v_dot2c_f32_bf16 v43, v147, v23
  v_dot2c_f32_bf16 v44, v148, v22
  v_dot2c_f32_bf16 v45, v148, v23
  v_dot2c_f32_bf16 v46, v149, v22
  v_dot2c_f32_bf16 v47, v149, v23
  v_dot2c_f32_bf16 v48, v150, v22
  v_dot2c_f32_bf16 v49, v150, v23
  v_dot2c_f32_bf16 v50, v151, v22
  v_dot2c_f32_bf16 v51, v151, v23
  v_dot2c_f32_bf16 v52, v152, v22
  v_dot2c_f32_bf16 v53, v152, v23
  v_dot2c_f32_bf16 v54, v153, v22
  v_dot2c_f32_bf16 v55, v153, v23
  v_dot2c_f32_bf16 v56, v154, v22
  v_dot2c_f32_bf16 v57, v154, v23
  v_dot2c_f32_bf16 v58, v155, v22
  v_dot2c_f32_bf16 v59, v155, v23
  s_branch S_done
S_drain1:
  s_waitcnt vmcnt(0)
  v_mov_b32 v13, 0
  v_mov_b32 v14, 0
  v_dot2c_f32_bf16 v13, v60, v24
  v_dot2c_f32_bf16 v14, v72, v24
  v_dot2c_f32_bf16 v13, v61, v25
  v_dot2c_f32_bf16 v14, v73, v25
  v_dot2c_f32_bf16 v13, v62, v26
  v_dot2c_f32_bf16 v14, v74, v26
  v_dot2c_f32_bf16 v13, v63, v27
  v_dot2c_f32_bf16 v14, v75, v27
  v_dot2c_f32_bf16 v13, v64, v28
  v_dot2c_f32_bf16 v14, v76, v28
  v_dot2c_f32_bf16 v13, v65, v29
  v_dot2c_f32_bf16 v14, v77, v29
  v_dot2c_f32_bf16 v13, v66, v30
  v_dot2c_f32_bf16 v14, v78, v30
  v_dot2c_f32_bf16 v13, v67, v31
  v_dot2c_f32_bf16 v14, v79, v31
  v_dot2c_f32_bf16 v13, v68, v32
  v_dot2c_f32_bf16 v14, v80, v32
  v_dot2c_f32_bf16 v13, v69, v33
  v_dot2c_f32_bf16 v14, v81, v33
  v_dot2c_f32_bf16 v13, v70, v34
  v_dot2c_f32_bf16 v14, v82, v34
  v_dot2c_f32_bf16 v13, v71, v35
  v_dot2c_f32_bf16 v14, v83, v35
  s_nop 1
  v_add_f32_dpp v13, v13, v13 quad_perm:[1,0,3,2] row_mask:0xf bank_mask:0xf
  v_add_f32_dpp v14, v14, v14 quad_perm:[1,0,3,2] row_mask:0xf bank_mask:0xf
  s_nop 0
  v_add_f32_dpp v13, v13, v13 quad_perm:[2,3,0,1] row_mask:0xf bank_mask:0xf
  v_add_f32_dpp v14, v14, v14 quad_perm:[2,3,0,1] row_mask:0xf bank_mask:0xf
  s_nop 0
  v_add_f32_dpp v13, v13, v13 row_half_mirror row_mask:0xf bank_mask:0xf
  v_add_f32_dpp v14, v14, v14 row_half_mirror row_mask:0xf bank_mask:0xf
  v_cvt_pk_bf16_f32 v15, v13, v14
  v_lshlrev_b32 v13, 16, v15
  v_and_b32 v14, 0xffff0000, v15
  v_mul_f32 v13, 0x3d93cd3a, v13
  v_mul_f32 v14, 0x3d93cd3a, v14
  v_cvt_pk_bf16_f32 v15, v13, v14
  v_lshlrev_b32 v13, 16, v15
  v_and_b32 v14, 0xffff0000, v15
  v_mul_f32 v13, 0x3fb8aa3b, v13
  v_mul_f32 v14, 0x3fb8aa3b, v14
  v_max3_f32 v16, v11, v13, v14
  s_nop 1
  v_max_f32_dpp v16, v16, v16 row_ror:8 row_mask:0xf bank_mask:0xf
  v_mov_b32 v17, v16
  s_nop 1
  v_permlane16_swap_b32 v16, v17
  v_max_f32 v16, v16, v17
  v_mov_b32 v17, v16
  s_nop 1
  v_permlane32_swap_b32 v16, v17
  v_max_f32 v16, v16, v17
  v_sub_f32 v18, v11, v16
  v_sub_f32 v13, v13, v16
  v_sub_f32 v14, v14, v16
  v_exp_f32 v18, v18
  v_exp_f32 v13, v13
  v_exp_f32 v14, v14
  v_mov_b32 v11, v16
  v_fma_f32 v12, v12, v18, v13
  v_cvt_pk_bf16_f32 v15, v13, v14
  v_add_f32 v12, v12, v14
  v_and_b32 v20, 0xffff, v15
  v_lshlrev_b32 v21, 16, v15
  v_lshrrev_b32 v22, 16, v15
  v_and_b32 v23, 0xffff0000, v15
  v_pk_mul_f32 v[36:37], v[36:37], v[18:19] op_sel_hi:[1,0]
  v_pk_mul_f32 v[38:39], v[38:39], v[18:19] op_sel_hi:[1,0]
  v_pk_mul_f32 v[40:41], v[40:41], v[18:19] op_sel_hi:[1,0]
  v_pk_mul_f32 v[42:43], v[42:43], v[18:19] op_sel_hi:[1,0]
  v_pk_mul_f32 v[44:45], v[44:45], v[18:19] op_sel_hi:[1,0]
  v_pk_mul_f32 v[46:47], v[46:47], v[18:19] op_sel_hi:[1,0]
  v_pk_mul_f32 v[48:49], v[48:49], v[18:19] op_sel_hi:[1,0]
  v_pk_mul_f32 v[50:51], v[50:51], v[18:19] op_sel_hi:[1,0]
  v_pk_mul_f32 v[52:53], v[52:53], v[18:19] op_sel_hi:[1,0]
  v_pk_mul_f32 v[54:55], v[54:55], v[18:19] op_sel_hi:[1,0]
  v_pk_mul_f32 v[56:57], v[56:57], v[18:19] op_sel_hi:[1,0]
  v_pk_mul_f32 v[58:59], v[58:59], v[18:19] op_sel_hi:[1,0]
  v_dot2c_f32_bf16 v36, v84, v20
  v_dot2c_f32_bf16 v37, v84, v21
  v_dot2c_f32_bf16 v38, v85, v20
  v_dot2c_f32_bf16 v39, v85, v21
  v_dot2c_f32_bf16 v40, v86, v20
  v_dot2c_f32_bf16 v41, v86, v21
  v_dot2c_f32_bf16 v42, v87, v20
  v_dot2c_f32_bf16 v43, v87, v21
  v_dot2c_f32_bf16 v44, v88, v20
  v_dot2c_f32_bf16 v45, v88, v21
  v_dot2c_f32_bf16 v46, v89, v20
  v_dot2c_f32_bf16 v47, v89, v21
  v_dot2c_f32_bf16 v48, v90, v20
  v_dot2c_f32_bf16 v49, v90, v21
  v_dot2c_f32_bf16 v50, v91, v20
  v_dot2c_f32_bf16 v51, v91, v21
  v_dot2c_f32_bf16 v52, v92, v20
  v_dot2c_f32_bf16 v53, v92, v21
  v_dot2c_f32_bf16 v54, v93, v20
  v_dot2c_f32_bf16 v55, v93, v21
  v_dot2c_f32_bf16 v56, v94, v20
  v_dot2c_f32_bf16 v57, v94, v21
  v_dot2c_f32_bf16 v58, v95, v20
  v_dot2c_f32_bf16 v59, v95, v21
  v_dot2c_f32_bf16 v36, v96, v22
  v_dot2c_f32_bf16 v37, v96, v23
  v_dot2c_f32_bf16 v38, v97, v22
  v_dot2c_f32_bf16 v39, v97, v23
  v_dot2c_f32_bf16 v40, v98, v22
  v_dot2c_f32_bf16 v41, v98, v23
  v_dot2c_f32_bf16 v42, v99, v22
  v_dot2c_f32_bf16 v43, v99, v23
  v_dot2c_f32_bf16 v44, v100, v22
  v_dot2c_f32_bf16 v45, v100, v23
  v_dot2c_f32_bf16 v46, v101, v22
  v_dot2c_f32_bf16 v47, v101, v23
  v_dot2c_f32_bf16 v48, v102, v22
  v_dot2c_f32_bf16 v49, v102, v23
  v_dot2c_f32_bf16 v50, v103, v22
  v_dot2c_f32_bf16 v51, v103, v23
  v_dot2c_f32_bf16 v52, v104, v22
  v_dot2c_f32_bf16 v53, v104, v23
  v_dot2c_f32_bf16 v54, v105, v22
  v_dot2c_f32_bf16 v55, v105, v23
  v_dot2c_f32_bf16 v56, v106, v22
  v_dot2c_f32_bf16 v57, v106, v23
  v_dot2c_f32_bf16 v58, v107, v22
  v_dot2c_f32_bf16 v59, v107, v23
S_done:
  v_mov_b32 v16, v11
  v_add_f32_dpp v12, v12, v12 row_ror:8 row_mask:0xf bank_mask:0xf
  v_permlane32_swap_b32 v36, v48
  v_permlane32_swap_b32 v37, v49
  v_permlane32_swap_b32 v38, v50
  v_permlane32_swap_b32 v39, v51
  v_permlane32_swap_b32 v40, v52
  v_permlane32_swap_b32 v41, v53
  v_permlane32_swap_b32 v42, v54
  v_permlane32_swap_b32 v43, v55
  v_permlane32_swap_b32 v44, v56
  v_permlane32_swap_b32 v45, v57
  v_permlane32_swap_b32 v46, v58
  v_permlane32_swap_b32 v47, v59
  v_mov_b32 v17, v12
  v_add_f32 v36, v36, v48
  v_add_f32 v37, v37, v49
  v_add_f32 v38, v38, v50
  v_add_f32 v39, v39, v51
  v_add_f32 v40, v40, v52
  v_add_f32 v41, v41, v53
  v_add_f32 v42, v42, v54
  v_add_f32 v43, v43, v55
  v_add_f32 v44, v44, v56
  v_add_f32 v45, v45, v57
  v_add_f32 v46, v46, v58
  v_add_f32 v47, v47, v59
  v_permlane16_swap_b32 v12, v17
  v_permlane16_swap_b32 v36, v42
  v_permlane16_swap_b32 v37, v43
  v_permlane16_swap_b32 v38, v44
  v_permlane16_swap_b32 v39, v45
  v_permlane16_swap_b32 v40, v46
  v_permlane16_swap_b32 v41, v47
  v_add_f32 v12, v12, v17
  v_mov_b32 v17, v12
  v_add_f32 v36, v36, v42
  v_add_f32 v37, v37, v43
  v_add_f32 v38, v38, v44
  v_add_f32 v39, v39, v45
  v_add_f32 v40, v40, v46
  v_add_f32 v41, v41, v47
  v_permlane32_swap_b32 v12, v17
  v_add_f32_dpp v36, v36, v36 row_ror:8 row_mask:0xf bank_mask:0xf
  v_add_f32_dpp v37, v37, v37 row_ror:8 row_mask:0xf bank_mask:0xf
  v_add_f32_dpp v38, v38, v38 row_ror:8 row_mask:0xf bank_mask:0xf
  v_add_f32_dpp v39, v39, v39 row_ror:8 row_mask:0xf bank_mask:0xf
  v_add_f32_dpp v40, v40, v40 row_ror:8 row_mask:0xf bank_mask:0xf
  v_add_f32_dpp v41, v41, v41 row_ror:8 row_mask:0xf bank_mask:0xf
  v_add_f32 v12, v12, v17
  s_mul_i32 s40, s31, 800
  s_add_u32 s40, s40, 7680
  v_lshrrev_b32 v2, 4, v1
  v_mul_u32_u24 v2, 192, v2
  v_and_b32 v3, 7, v1
  v_lshl_add_u32 v2, v3, 2, v2
  v_add_u32 v2, s40, v2
  ds_write_b32 v2, v36 offset:0
  ds_write_b32 v2, v37 offset:32
  ds_write_b32 v2, v38 offset:64
  ds_write_b32 v2, v39 offset:96
  ds_write_b32 v2, v40 offset:128
  ds_write_b32 v2, v41 offset:160
  v_mov_b32 v3, s40
  v_mov_b32 v17, v12
  ds_write_b64 v3, v[16:17] offset:768
  s_waitcnt lgkmcnt(0)
  s_barrier
  s_endpgm
A_n:
  s_cmp_eq_u32 s30, 7
  s_cbranch_scc0 A_n0
  s_mov_b32 s32, s4
  s_mov_b32 s33, s5
  s_mov_b32 s34, 5120
  s_mov_b32 s35, 0x20000
  s_mul_i32 s40, s31, 1280
  v_lshl_add_u32 v3, v1, 2, s40
  buffer_load_dword v10, v3, s[32:35], 0 offen offset:0
  buffer_load_dword v11, v3, s[32:35], 0 offen offset:256
  buffer_load_dword v12, v3, s[32:35], 0 offen offset:512
  buffer_load_dword v13, v3, s[32:35], 0 offen offset:768
  buffer_load_dword v14, v3, s[32:35], 0 offen offset:1024
A_n0:
  s_waitcnt lgkmcnt(0)
  s_barrier
  s_add_u32 s60, s60, 1
  s_not_b32 s61, s60
  s_mov_b32 s57, 0x3ff
  v_mov_b32 v159, s60
  s_cmp_eq_u32 s30, 7
  s_cbranch_scc0 A_n1
  s_waitcnt vmcnt(0)
  v_lshlrev_b32 v20, 16, v10
  v_and_b32 v21, 0xffff0000, v10
  v_lshlrev_b32 v22, 16, v11
  v_and_b32 v23, 0xffff0000, v11
  v_lshlrev_b32 v24, 16, v12
  v_and_b32 v25, 0xffff0000, v12
  v_lshlrev_b32 v26, 16, v13
  v_and_b32 v27, 0xffff0000, v13
  v_lshlrev_b32 v28, 16, v14
  v_and_b32 v29, 0xffff0000, v14
  v_add_f32 v30, v20, v21
  v_add_f32 v30, v30, v22
  v_add_f32 v30, v30, v23
  v_add_f32 v30, v30, v24
  v_add_f32 v30, v30, v25
  v_add_f32 v30, v30, v26
  v_add_f32 v30, v30, v27
  v_add_f32 v30, v30, v28
  v_add_f32 v30, v30, v29
  s_nop 1
  v_add_f32_dpp v30, v30, v30 quad_perm:[1,0,3,2] row_mask:0xf bank_mask:0xf
  s_nop 1
  v_add_f32_dpp v30, v30, v30 quad_perm:[2,3,0,1] row_mask:0xf bank_mask:0xf
  s_nop 1
  v_add_f32_dpp v30, v30, v30 row_half_mirror row_mask:0xf bank_mask:0xf
  s_nop 1
  v_add_f32_dpp v30, v30, v30 row_mirror row_mask:0xf bank_mask:0xf
  v_mov_b32 v31, v30
  s_nop 1
  v_permlane16_swap_b32 v30, v31
  v_add_f32 v30, v30, v31
  v_mov_b32 v31, v30
  s_nop 1
  v_permlane32_swap_b32 v30, v31
  v_add_f32 v30, v30, v31
  v_mul_f32 v30, 0x3acccccd, v30
  v_sub_f32 v32, v20, v30
  v_mul_f32 v33, v32, v32
  v_sub_f32 v32, v21, v30
  v_fmac_f32 v33, v32, v32
  v_sub_f32 v32, v22, v30
  v_fmac_f32 v33, v32, v32
  v_sub_f32 v32, v23, v30
  v_fmac_f32 v33, v32, v32
  v_sub_f32 v32, v24, v30
  v_fmac_f32 v33, v32, v32
  v_sub_f32 v32, v25, v30
  v_fmac_f32 v33, v32, v32
  v_sub_f32 v32, v26, v30
  v_fmac_f32 v33, v32, v32
  v_sub_f32 v32, v27, v30
  v_fmac_f32 v33, v32, v32
  v_sub_f32 v32, v28, v30
  v_fmac_f32 v33, v32, v32
  v_sub_f32 v32, v29, v30
  v_fmac_f32 v33, v32, v32
  s_nop 1
  v_add_f32_dpp v33, v33, v33 quad_perm:[1,0,3,2] row_mask:0xf bank_mask:0xf
  s_nop 1
  v_add_f32_dpp v33, v33, v33 quad_perm:[2,3,0,1] row_mask:0xf bank_mask:0xf
  s_nop 1
  v_add_f32_dpp v33, v33, v33 row_half_mirror row_mask:0xf bank_mask:0xf
  s_nop 1
  v_add_f32_dpp v33, v33, v33 row_mirror row_mask:0xf bank_mask:0xf
  v_mov_b32 v31, v33
  s_nop 1
  v_permlane16_swap_b32 v33, v31
  v_add_f32 v33, v33, v31
  v_mov_b32 v31, v33
  s_nop 1
  v_permlane32_swap_b32 v33, v31
  v_add_f32 v33, v33, v31
  v_mul_f32 v33, 0x3acccccd, v33
  v_cvt_pk_bf16_f32 v33, v33, v33
  v_and_b32 v33, 0xffff0000, v33
  v_add_f32 v33, 0x3727c5ac, v33
  v_cvt_pk_bf16_f32 v33, v33, v33
  v_and_b32 v33, 0xffff0000, v33
  v_sqrt_f32 v33, v33
  s_nop 0
  v_cvt_pk_bf16_f32 v33, v33, v33
  v_and_b32 v33, 0xffff0000, v33
  v_rcp_f32 v34, v33
  v_cvt_pk_bf16_f32 v30, v30, v30
  v_and_b32 v30, 0xffff0000, v30
  v_sub_f32 v20, v20, v30
  v_sub_f32 v21, v21, v30
  v_sub_f32 v22, v22, v30
  v_sub_f32 v23, v23, v30
  v_sub_f32 v24, v24, v30
  v_sub_f32 v25, v25, v30
  v_sub_f32 v26, v26, v30
  v_sub_f32 v27, v27, v30
  v_sub_f32 v28, v28, v30
  v_sub_f32 v29, v29, v30
  v_cvt_pk_bf16_f32 v35, v20, v21
  v_lshlrev_b32 v20, 16, v35
  v_and_b32 v21, 0xffff0000, v35
  v_cvt_pk_bf16_f32 v35, v22, v23
  v_lshlrev_b32 v22, 16, v35
  v_and_b32 v23, 0xffff0000, v35
  v_cvt_pk_bf16_f32 v35, v24, v25
  v_lshlrev_b32 v24, 16, v35
  v_and_b32 v25, 0xffff0000, v35
  v_cvt_pk_bf16_f32 v35, v26, v27
  v_lshlrev_b32 v26, 16, v35
  v_and_b32 v27, 0xffff0000, v35
  v_cvt_pk_bf16_f32 v35, v28, v29
  v_lshlrev_b32 v28, 16, v35
  v_and_b32 v29, 0xffff0000, v35
  v_mul_f32 v35, v20, v34
  v_fma_f32 v36, -v35, v33, v20
  v_fma_f32 v20, v36, v34, v35
  v_mul_f32 v35, v21, v34
  v_fma_f32 v36, -v35, v33, v21
  v_fma_f32 v21, v36, v34, v35
  v_mul_f32 v35, v22, v34
  v_fma_f32 v36, -v35, v33, v22
  v_fma_f32 v22, v36, v34, v35
  v_mul_f32 v35, v23, v34
  v_fma_f32 v36, -v35, v33, v23
  v_fma_f32 v23, v36, v34, v35
  v_mul_f32 v35, v24, v34
  v_fma_f32 v36, -v35, v33, v24
  v_fma_f32 v24, v36, v34, v35
  v_mul_f32 v35, v25, v34
  v_fma_f32 v36, -v35, v33, v25
  v_fma_f32 v25, v36, v34, v35
  v_mul_f32 v35, v26, v34
  v_fma_f32 v36, -v35, v33, v26
  v_fma_f32 v26, v36, v34, v35
  v_mul_f32 v35, v27, v34
  v_fma_f32 v36, -v35, v33, v27
  v_fma_f32 v27, v36, v34, v35
  v_mul_f32 v35, v28, v34
  v_fma_f32 v36, -v35, v33, v28
  v_fma_f32 v28, v36, v34, v35
  v_mul_f32 v35, v29, v34
  v_fma_f32 v36, -v35, v33, v29
  v_fma_f32 v29, v36, v34, v35
  s_mul_i32 s40, s31, 1344
  v_lshl_add_u32 v3, v1, 2, s40
  v_cvt_pk_bf16_f32 v35, v20, v21
  ds_write_b32 v3, v35 offset:0
  v_cvt_pk_bf16_f32 v35, v22, v23
  ds_write_b32 v3, v35 offset:256
  v_cvt_pk_bf16_f32 v35, v24, v25
  ds_write_b32 v3, v35 offset:512
  v_cvt_pk_bf16_f32 v35, v26, v27
  ds_write_b32 v3, v35 offset:768
  v_cvt_pk_bf16_f32 v35, v28, v29
  ds_write_b32 v3, v35 offset:1024
A_n1:
  v_cmp_gt_u32 vcc, 96, v0
  s_nop 0
  s_and_saveexec_b64 s[80:81], vcc
  s_cbranch_execz L_qg_16
  s_mul_i32 s82, s28, 12288
  s_mul_i32 s83, s55, 1536
  s_add_u32 s82, s82, s83
  s_add_u32 s82, s82, 65536
  v_lshl_add_u32 v12, v0, 4, s82
  v_add_u32 v13, 6144, v12
  s_mov_b32 s79, 32768
L_poll_17:
  global_load_dwordx4 v[16:19], v12, s[26:27] sc1
  global_load_dwordx4 v[20:23], v13, s[26:27] sc1
  s_waitcnt vmcnt(0)
  v_xor_b32 v7, s60, v17
  v_xor_b32 v8, s61, v19
  v_or_b32 v9, v7, v8
  v_xor_b32 v7, s60, v21
  v_xor_b32 v8, s61, v23
  v_or3_b32 v9, v9, v7, v8
  v_cmp_ne_u32 vcc, 0, v9
  s_nop 0
  s_cmp_lg_u64 vcc, 0
  s_cbranch_scc0 L_pollx_18
  s_sleep 1
  s_sub_u32 s79, s79, 1
  s_cbranch_scc0 L_poll_17
  v_mov_b32 v2, 8
  v_mov_b32 v3, 1
  global_store_dword v2, v3, s[24:25]
L_pollx_18:
  v_add_f32 v16, v16, v20
  v_add_f32 v18, v18, v22
  v_cvt_pk_bf16_f32 v16, v16, v18
  v_lshlrev_b32 v12, 2, v0
  ds_write_b32 v12, v16 offset:5440
L_qg_16:
  s_mov_b64 exec, s[80:81]
  s_waitcnt lgkmcnt(0)
  s_barrier
  s_waitcnt lgkmcnt(0)
  s_add_u32 s58, s58, 4
  v_mov_b32 v2, 5376
  v_mov_b32 v3, 1
  s_mov_b64 exec, 1
  ds_add_u32 v2, v3
  s_mov_b64 exec, -1
  s_mov_b32 s79, 524288
L_ab_19:
  ds_read_b32 v4, v2
  s_waitcnt lgkmcnt(0)
  v_readfirstlane_b32 s78, v4
  s_nop 0
  s_cmp_ge_u32 s78, s58
  s_cbranch_scc1 L_abx_20
  s_sleep 1
  s_sub_u32 s79, s79, 1
  s_cbranch_scc0 L_ab_19
  v_mov_b32 v2, 4
  v_mov_b32 v3, 1
  global_store_dword v2, v3, s[24:25]
L_abx_20:
  s_cmp_eq_u32 s30, 7
  s_cbranch_scc1 A_f1
  s_branch A_tail
A_f2:
  s_cmp_ge_u32 s28, 30
  s_cbranch_scc1 A_tail
  s_mul_i32 s41, s28, 26
  s_lshr_b32 s41, s41, 8
  s_mul_i32 s42, s41, 10
  s_sub_u32 s43, s28, s42
  s_mov_b32 s36, s20
  s_mov_b32 s37, s21
  s_mov_b32 s38, 1966080
  s_mov_b32 s39, 0x20000
  v_lshrrev_b32 v2, 3, v1
  v_and_b32 v3, 6, v2
  v_and_b32 v40, 7, v1
  v_xor_b32 v40, v40, v3
  v_lshlrev_b32 v40, 4, v40
  s_mov_b32 s40, 1280
  v_mad_u32_u24 v40, v2, s40, v40
  s_mul_i32 s44, s41, 655360
  s_lshl_b32 s45, s43, 7
  s_add_u32 s44, s44, s45
  s_mul_i32 s45, s31, 10240
  s_add_u32 s44, s44, s45
  s_lshl_b32 s45, s31, 10
  s_add_u32 s45, s45, 20480
  s_mov_b32 m0, s45
  s_nop 0
  buffer_load_dwordx4 v40, s[36:39], s44 offen nt lds
  s_add_u32 s44, s44, 40960
  s_add_u32 s45, s45, 4096
  s_mov_b32 m0, s45
  s_nop 0
  buffer_load_dwordx4 v40, s[36:39], s44 offen nt lds
  s_add_u32 s44, s44, 40960
  s_add_u32 s45, s45, 4096
  s_mov_b32 m0, s45
  s_nop 0
  buffer_load_dwordx4 v40, s[36:39], s44 offen nt lds
  s_add_u32 s44, s44, 40960
  s_add_u32 s45, s45, 4096
  s_mov_b32 m0, s45
  s_nop 0
  buffer_load_dwordx4 v40, s[36:39], s44 offen nt lds
  s_add_u32 s44, s44, 40960
  s_add_u32 s45, s45, 4096
  s_mov_b32 m0, s45
  s_nop 0
  buffer_load_dwordx4 v40, s[36:39], s44 offen nt lds
  s_add_u32 s44, s44, 40960
  s_add_u32 s45, s45, 4096
  s_mov_b32 m0, s45
  s_nop 0
  buffer_load_dwordx4 v40, s[36:39], s44 offen nt lds
  s_add_u32 s44, s44, 40960
  s_add_u32 s45, s45, 4096
  s_mov_b32 m0, s45
  s_nop 0
  buffer_load_dwordx4 v40, s[36:39], s44 offen nt lds
  s_add_u32 s44, s44, 40960
  s_add_u32 s45, s45, 4096
  s_mov_b32 m0, s45
  s_nop 0
  buffer_load_dwordx4 v40, s[36:39], s44 offen nt lds
  s_add_u32 s44, s44, 40960
  s_add_u32 s45, s45, 4096
  s_mov_b32 m0, s45
  s_nop 0
  buffer_load_dwordx4 v40, s[36:39], s44 offen nt lds
  s_add_u32 s44, s44, 40960
  s_add_u32 s45, s45, 4096
  s_mov_b32 m0, s45
  s_nop 0
  buffer_load_dwordx4 v40, s[36:39], s44 offen nt lds
  s_add_u32 s44, s44, 40960
  s_add_u32 s45, s45, 4096
  s_mov_b32 m0, s45
  s_nop 0
  buffer_load_dwordx4 v40, s[36:39], s44 offen nt lds
  s_add_u32 s44, s44, 40960
  s_add_u32 s45, s45, 4096
  s_mov_b32 m0, s45
  s_nop 0
  buffer_load_dwordx4 v40, s[36:39], s44 offen nt lds
  s_add_u32 s44, s44, 40960
  s_add_u32 s45, s45, 4096
  s_mov_b32 m0, s45
  s_nop 0
  buffer_load_dwordx4 v40, s[36:39], s44 offen nt lds
  s_add_u32 s44, s44, 40960
  s_add_u32 s45, s45, 4096
  s_mov_b32 m0, s45
  s_nop 0
  buffer_load_dwordx4 v40, s[36:39], s44 offen nt lds
  s_add_u32 s44, s44, 40960
  s_add_u32 s45, s45, 4096
  s_mov_b32 m0, s45
  s_nop 0
  buffer_load_dwordx4 v40, s[36:39], s44 offen nt lds
  s_add_u32 s44, s44, 40960
  s_add_u32 s45, s45, 4096
  s_mov_b32 m0, s45
  s_nop 0
  buffer_load_dwordx4 v40, s[36:39], s44 offen nt lds
  s_lshl_b32 s44, s41, 13
  s_add_u32 s44, s44, 1048576
  v_lshl_add_u32 v12, v0, 4, s44
  v_add_u32 v13, 4096, v12
  s_mov_b32 s79, 32768
L_poll_21:
  global_load_dwordx4 v[16:19], v12, s[26:27] sc1
  global_load_dwordx4 v[20:23], v13, s[26:27] sc1
  s_waitcnt vmcnt(0)
  v_xor_b32 v7, s60, v17
  v_xor_b32 v8, s61, v19
  v_or_b32 v9, v7, v8
  v_xor_b32 v7, s60, v21
  v_xor_b32 v8, s61, v23
  v_or3_b32 v9, v9, v7, v8
  v_cmp_ne_u32 vcc, 0, v9
  s_nop 0
  s_cmp_lg_u64 vcc, 0
  s_cbranch_scc0 L_pollx_22
  s_sleep 96
  s_sub_u32 s79, s79, 1
  s_cbranch_scc0 L_poll_21
  v_mov_b32 v2, 36
  v_mov_b32 v3, 1
  global_store_dword v2, v3, s[24:25]
L_pollx_22:
  v_lshrrev_b32 v2, 6, v0
  v_bfe_u32 v3, v0, 4, 2
  v_and_b32 v4, 15, v0
  v_mul_u32_u24 v3, 1040, v3
  v_lshl_add_u32 v3, v2, 7, v3
  v_lshl_add_u32 v3, v4, 3, v3
  v_mov_b32 v17, v18
  v_mov_b32 v21, v22
  ds_write_b64 v3, v[16:17] offset:11264
  ds_write_b64 v3, v[20:21] offset:11776
  s_waitcnt lgkmcnt(0)
  s_add_u32 s58, s58, 4
  v_mov_b32 v2, 5376
  v_mov_b32 v3, 1
  s_mov_b64 exec, 1
  ds_add_u32 v2, v3
  s_mov_b64 exec, -1
  s_mov_b32 s79, 524288
L_ab_23:
  ds_read_b32 v4, v2
  s_waitcnt lgkmcnt(0)
  v_readfirstlane_b32 s78, v4
  s_nop 0
  s_cmp_ge_u32 s78, s58
  s_cbranch_scc1 L_abx_24
  s_sleep 1
  s_sub_u32 s79, s79, 1
  s_cbranch_scc0 L_ab_23
  v_mov_b32 v2, 4
  v_mov_b32 v3, 1
  global_store_dword v2, v3, s[24:25]
L_abx_24:
  v_lshrrev_b32 v2, 2, v1
  v_bfe_u32 v3, v1, 1, 1
  s_lshl_b32 s40, s31, 1
  v_or_b32 v3, s40, v3
  v_and_b32 v41, 6, v2
  v_xor_b32 v3, v3, v41
  v_lshlrev_b32 v3, 4, v3
  v_lshl_add_u32 v3, v2, 7, v3
  v_and_b32 v41, 1, v1
  v_lshl_add_u32 v41, v41, 3, v3
  v_add_u32 v41, 20480, v41
  v_and_b32 v2, 3, v1
  s_mov_b32 s40, 1040
  v_mul_u32_u24 v45, s40, v2
  v_lshrrev_b32 v2, 4, v1
  v_lshl_add_u32 v45, v2, 3, v45
  v_add_u32 v45, 11264, v45
  ds_read_b64 v[60:61], v45 offset:0
  ds_read_b64 v[62:63], v45 offset:32
  ds_read_b64_tr_b16 v[64:65], v41 offset:0
  ds_read_b64_tr_b16 v[66:67], v41 offset:2048
  ds_read_b64 v[68:69], v45 offset:64
  ds_read_b64 v[70:71], v45 offset:96
  ds_read_b64_tr_b16 v[72:73], v41 offset:4096
  ds_read_b64_tr_b16 v[74:75], v41 offset:6144
  ds_read_b64 v[76:77], v45 offset:128
  ds_read_b64 v[78:79], v45 offset:160
  ds_read_b64_tr_b16 v[80:81], v41 offset:8192
  ds_read_b64_tr_b16 v[82:83], v41 offset:10240
  ds_read_b64 v[84:85], v45 offset:192
  ds_read_b64 v[86:87], v45 offset:224
  ds_read_b64_tr_b16 v[88:89], v41 offset:12288
  ds_read_b64_tr_b16 v[90:91], v41 offset:14336
  ds_read_b64 v[92:93], v45 offset:256
  ds_read_b64 v[94:95], v45 offset:288
  ds_read_b64_tr_b16 v[96:97], v41 offset:16384
  ds_read_b64_tr_b16 v[98:99], v41 offset:18432
  ds_read_b64 v[100:101], v45 offset:320
  ds_read_b64 v[102:103], v45 offset:352
  ds_read_b64_tr_b16 v[104:105], v41 offset:20480
  ds_read_b64_tr_b16 v[106:107], v41 offset:22528
  ds_read_b64 v[108:109], v45 offset:384
  ds_read_b64 v[110:111], v45 offset:416
  ds_read_b64_tr_b16 v[112:113], v41 offset:24576
  ds_read_b64_tr_b16 v[114:115], v41 offset:26624
  ds_read_b64 v[116:117], v45 offset:448
  ds_read_b64 v[118:119], v45 offset:480
  ds_read_b64_tr_b16 v[120:121], v41 offset:28672
  ds_read_b64_tr_b16 v[122:123], v41 offset:30720
  s_waitcnt lgkmcnt(0)
  v_mfma_f32_16x16x32_bf16 v[48:51], v[64:67], v[60:63], 0
  v_mfma_f32_16x16x32_bf16 v[48:51], v[72:75], v[68:71], v[48:51]
  v_mfma_f32_16x16x32_bf16 v[48:51], v[80:83], v[76:79], v[48:51]
  v_mfma_f32_16x16x32_bf16 v[48:51], v[88:91], v[84:87], v[48:51]
  v_mfma_f32_16x16x32_bf16 v[48:51], v[96:99], v[92:95], v[48:51]
  v_mfma_f32_16x16x32_bf16 v[48:51], v[104:107], v[100:103], v[48:51]
  v_mfma_f32_16x16x32_bf16 v[48:51], v[112:115], v[108:111], v[48:51]
  v_mfma_f32_16x16x32_bf16 v[48:51], v[120:123], v[116:119], v[48:51]
  ds_read_b64 v[60:61], v45 offset:512
  ds_read_b64 v[62:63], v45 offset:544
  ds_read_b64_tr_b16 v[64:65], v41 offset:32768
  ds_read_b64_tr_b16 v[66:67], v41 offset:34816
  ds_read_b64 v[68:69], v45 offset:576
  ds_read_b64 v[70:71], v45 offset:608
  ds_read_b64_tr_b16 v[72:73], v41 offset:36864
  ds_read_b64_tr_b16 v[74:75], v41 offset:38912
  ds_read_b64 v[76:77], v45 offset:640
  ds_read_b64 v[78:79], v45 offset:672
  ds_read_b64_tr_b16 v[80:81], v41 offset:40960
  ds_read_b64_tr_b16 v[82:83], v41 offset:43008
  ds_read_b64 v[84:85], v45 offset:704
  ds_read_b64 v[86:87], v45 offset:736
  ds_read_b64_tr_b16 v[88:89], v41 offset:45056
  ds_read_b64_tr_b16 v[90:91], v41 offset:47104
  ds_read_b64 v[92:93], v45 offset:768
  ds_read_b64 v[94:95], v45 offset:800
  ds_read_b64_tr_b16 v[96:97], v41 offset:49152
  ds_read_b64_tr_b16 v[98:99], v41 offset:51200
  ds_read_b64 v[100:101], v45 offset:832
  ds_read_b64 v[102:103], v45 offset:864
  ds_read_b64_tr_b16 v[104:105], v41 offset:53248
  ds_read_b64_tr_b16 v[106:107], v41 offset:55296
  ds_read_b64 v[108:109], v45 offset:896
  ds_read_b64 v[110:111], v45 offset:928
  ds_read_b64_tr_b16 v[112:113], v41 offset:57344
  ds_read_b64_tr_b16 v[114:115], v41 offset:59392
  ds_read_b64 v[116:117], v45 offset:960
  ds_read_b64 v[118:119], v45 offset:992
  ds_read_b64_tr_b16 v[120:121], v41 offset:61440
  ds_read_b64_tr_b16 v[122:123], v41 offset:63488
  s_waitcnt lgkmcnt(0)
  v_mfma_f32_16x16x32_bf16 v[48:51], v[64:67], v[60:63], v[48:51]
  v_mfma_f32_16x16x32_bf16 v[48:51], v[72:75], v[68:71], v[48:51]
  v_mfma_f32_16x16x32_bf16 v[48:51], v[80:83], v[76:79], v[48:51]
  v_mfma_f32_16x16x32_bf16 v[48:51], v[88:91], v[84:87], v[48:51]
  v_mfma_f32_16x16x32_bf16 v[48:51], v[96:99], v[92:95], v[48:51]
  v_mfma_f32_16x16x32_bf16 v[48:51], v[104:107], v[100:103], v[48:51]
  v_mfma_f32_16x16x32_bf16 v[48:51], v[112:115], v[108:111], v[48:51]
  v_mfma_f32_16x16x32_bf16 v[48:51], v[120:123], v[116:119], v[48:51]
  s_mul_i32 s44, s43, 3
  s_add_u32 s44, s44, s41
  s_lshl_b32 s44, s44, 10
  s_lshl_b32 s45, s31, 6
  s_add_u32 s44, s44, s45
  s_add_u32 s44, s44, 1081344
  v_and_b32 v2, 3, v1
  v_lshlrev_b32 v2, 8, v2
  v_lshrrev_b32 v3, 4, v1
  v_lshl_add_u32 v6, v3, 4, v2
  v_add_u32 v6, s44, v6
  v_add_u32 v52, 0x200, v48
  v_bfi_b32 v52, s57, v159, v52
  v_add_u32 v53, 0x200, v49
  v_bfi_b32 v53, s57, v159, v53
  v_add_u32 v54, 0x200, v50
  v_bfi_b32 v54, s57, v159, v54
  v_add_u32 v55, 0x200, v51
  v_bfi_b32 v55, s57, v159, v55
  s_mov_b32 exec_lo, 0x000f000f
  s_mov_b32 exec_hi, 0x000f000f
  global_store_dwordx4 v6, v[52:55], s[26:27] sc1
  s_mov_b64 exec, -1
  s_branch A_tail
A_f1:
  s_cmp_ge_u32 s28, 24
  s_cbranch_scc1 A_tail
  s_mov_b32 s36, s16
  s_mov_b32 s37, s17
  s_mov_b32 s38, 1966080
  s_mov_b32 s39, 0x20000
  s_mov_b32 s44, s18
  s_mov_b32 s45, s19
  s_mov_b32 s46, 1966080
  s_mov_b32 s47, 0x20000
  s_mul_i32 s48, s31, 491520
  s_lshl_b32 s40, s28, 7
  s_add_u32 s48, s48, s40
  s_mul_i32 s49, s31, 24576
  s_add_u32 s49, s49, 20480
  v_lshrrev_b32 v2, 3, v1
  v_and_b32 v3, 6, v2
  v_and_b32 v40, 7, v1
  v_xor_b32 v40, v40, v3
  v_lshlrev_b32 v40, 4, v40
  s_mov_b32 s40, 3072
  v_mad_u32_u24 v40, v2, s40, v40
  s_add_u32 s50, s48, 0
  s_add_u32 s51, s49, 0
  s_mov_b32 m0, s51
  s_nop 0
  buffer_load_dwordx4 v40, s[36:39], s50 offen nt lds
  s_add_u32 s50, s48, 24576
  s_add_u32 s51, s49, 1024
  s_mov_b32 m0, s51
  s_nop 0
  buffer_load_dwordx4 v40, s[36:39], s50 offen nt lds
  s_add_u32 s50, s48, 49152
  s_add_u32 s51, s49, 2048
  s_mov_b32 m0, s51
  s_nop 0
  buffer_load_dwordx4 v40, s[36:39], s50 offen nt lds
  s_add_u32 s50, s48, 73728
  s_add_u32 s51, s49, 3072
  s_mov_b32 m0, s51
  s_nop 0
  buffer_load_dwordx4 v40, s[36:39], s50 offen nt lds
  s_add_u32 s50, s48, 0
  s_add_u32 s51, s49, 4096
  s_mov_b32 m0, s51
  s_nop 0
  buffer_load_dwordx4 v40, s[44:47], s50 offen nt lds
  s_add_u32 s50, s48, 24576
  s_add_u32 s51, s49, 5120
  s_mov_b32 m0, s51
  s_nop 0
  buffer_load_dwordx4 v40, s[44:47], s50 offen nt lds
  s_add_u32 s50, s48, 49152
  s_add_u32 s51, s49, 6144
  s_mov_b32 m0, s51
  s_nop 0
  buffer_load_dwordx4 v40, s[44:47], s50 offen nt lds
  s_add_u32 s50, s48, 73728
  s_add_u32 s51, s49, 7168
  s_mov_b32 m0, s51
  s_nop 0
  buffer_load_dwordx4 v40, s[44:47], s50 offen nt lds
  s_add_u32 s50, s48, 98304
  s_add_u32 s51, s49, 8192
  s_mov_b32 m0, s51
  s_nop 0
  buffer_load_dwordx4 v40, s[36:39], s50 offen nt lds
  s_add_u32 s50, s48, 122880
  s_add_u32 s51, s49, 9216
  s_mov_b32 m0, s51
  s_nop 0
  buffer_load_dwordx4 v40, s[36:39], s50 offen nt lds
  s_add_u32 s50, s48, 147456
  s_add_u32 s51, s49, 10240
  s_mov_b32 m0, s51
  s_nop 0
  buffer_load_dwordx4 v40, s[36:39], s50 offen nt lds
  s_add_u32 s50, s48, 172032
  s_add_u32 s51, s49, 11264
  s_mov_b32 m0, s51
  s_nop 0
  buffer_load_dwordx4 v40, s[36:39], s50 offen nt lds
  s_add_u32 s50, s48, 98304
  s_add_u32 s51, s49, 12288
  s_mov_b32 m0, s51
  s_nop 0
  buffer_load_dwordx4 v40, s[44:47], s50 offen nt lds
  s_add_u32 s50, s48, 122880
  s_add_u32 s51, s49, 13312
  s_mov_b32 m0, s51
  s_nop 0
  buffer_load_dwordx4 v40, s[44:47], s50 offen nt lds
  s_add_u32 s50, s48, 147456
  s_add_u32 s51, s49, 14336
  s_mov_b32 m0, s51
  s_nop 0
  buffer_load_dwordx4 v40, s[44:47], s50 offen nt lds
  s_add_u32 s50, s48, 172032
  s_add_u32 s51, s49, 15360
  s_mov_b32 m0, s51
  s_nop 0
  buffer_load_dwordx4 v40, s[44:47], s50 offen nt lds
  s_add_u32 s50, s48, 196608
  s_add_u32 s51, s49, 16384
  s_mov_b32 m0, s51
  s_nop 0
  buffer_load_dwordx4 v40, s[36:39], s50 offen nt lds
  s_add_u32 s50, s48, 221184
  s_add_u32 s51, s49, 17408
  s_mov_b32 m0, s51
  s_nop 0
  buffer_load_dwordx4 v40, s[36:39], s50 offen nt lds
  s_add_u32 s50, s48, 245760
  s_add_u32 s51, s49, 18432
  s_mov_b32 m0, s51
  s_nop 0
  buffer_load_dwordx4 v40, s[36:39], s50 offen nt lds
  s_add_u32 s50, s48, 270336
  s_add_u32 s51, s49, 19456
  s_mov_b32 m0, s51
  s_nop 0
  buffer_load_dwordx4 v40, s[36:39], s50 offen nt lds
  s_add_u32 s50, s48, 196608
  s_add_u32 s51, s49, 20480
  s_mov_b32 m0, s51
  s_nop 0
  buffer_load_dwordx4 v40, s[44:47], s50 offen nt lds
  s_add_u32 s50, s48, 221184
  s_add_u32 s51, s49, 21504
  s_mov_b32 m0, s51
  s_nop 0
  buffer_load_dwordx4 v40, s[44:47], s50 offen nt lds
  s_add_u32 s50, s48, 245760
  s_add_u32 s51, s49, 22528
  s_mov_b32 m0, s51
  s_nop 0
  buffer_load_dwordx4 v40, s[44:47], s50 offen nt lds
  s_add_u32 s50, s48, 270336
  s_add_u32 s51, s49, 23552
  s_mov_b32 m0, s51
  s_nop 0
  buffer_load_dwordx4 v40, s[44:47], s50 offen nt lds
  v_lshrrev_b32 v2, 2, v1
  v_bfe_u32 v3, v1, 1, 1
  v_and_b32 v41, 6, v2
  v_xor_b32 v3, v3, v41
  v_lshlrev_b32 v3, 4, v3
  v_lshl_add_u32 v3, v2, 7, v3
  v_and_b32 v41, 1, v1
  v_lshl_add_u32 v41, v41, 3, v3
  v_add_u32 v41, s49, v41
  v_lshrrev_b32 v2, 2, v1
  v_bfe_u32 v3, v1, 1, 1
  v_or_b32 v3, 2, v3
  v_and_b32 v42, 6, v2
  v_xor_b32 v3, v3, v42
  v_lshlrev_b32 v3, 4, v3
  v_lshl_add_u32 v3, v2, 7, v3
  v_and_b32 v42, 1, v1
  v_lshl_add_u32 v42, v42, 3, v3
  v_add_u32 v42, s49, v42
  v_lshrrev_b32 v2, 2, v1
  v_bfe_u32 v3, v1, 1, 1
  v_or_b32 v3, 4, v3
  v_and_b32 v43, 6, v2
  v_xor_b32 v3, v3, v43
  v_lshlrev_b32 v3, 4, v3
  v_lshl_add_u32 v3, v2, 7, v3
  v_and_b32 v43, 1, v1
  v_lshl_add_u32 v43, v43, 3, v3
  v_add_u32 v43, s49, v43
  v_lshrrev_b32 v2, 2, v1
  v_bfe_u32 v3, v1, 1, 1
  v_or_b32 v3, 6, v3
  v_and_b32 v44, 6, v2
  v_xor_b32 v3, v3, v44
  v_lshlrev_b32 v3, 4, v3
  v_lshl_add_u32 v3, v2, 7, v3
  v_and_b32 v44, 1, v1
  v_lshl_add_u32 v44, v44, 3, v3
  v_add_u32 v44, s49, v44
  v_and_b32 v2, 3, v1
  s_mov_b32 s40, 1344
  v_mul_u32_u24 v45, s40, v2
  v_lshrrev_b32 v2, 4, v1
  v_lshl_add_u32 v45, v2, 3, v45
  s_mul_i32 s40, s31, 320
  s_add_u32 s40, s40, 0
  v_add_u32 v45, s40, v45
  v_mov_b32 v48, 0
  v_mov_b32 v49, 0
  v_mov_b32 v50, 0
  v_mov_b32 v51, 0
  v_mov_b32 v52, 0
  v_mov_b32 v53, 0
  v_mov_b32 v54, 0
  v_mov_b32 v55, 0
  v_mov_b32 v56, 0
  v_mov_b32 v57, 0
  v_mov_b32 v58, 0
  v_mov_b32 v59, 0
  v_mov_b32 v60, 0
  v_mov_b32 v61, 0
  v_mov_b32 v62, 0
  v_mov_b32 v63, 0
  v_mov_b32 v64, 0
  v_mov_b32 v65, 0
  v_mov_b32 v66, 0
  v_mov_b32 v67, 0
  v_mov_b32 v68, 0
  v_mov_b32 v69, 0
  v_mov_b32 v70, 0
  v_mov_b32 v71, 0
  v_mov_b32 v72, 0
  v_mov_b32 v73, 0
  v_mov_b32 v74, 0
  v_mov_b32 v75, 0
  v_mov_b32 v76, 0
  v_mov_b32 v77, 0
  v_mov_b32 v78, 0
  v_mov_b32 v79, 0
  s_waitcnt vmcnt(16)
  ds_read_b64 v[80:81], v45 offset:0
  ds_read_b64 v[82:83], v45 offset:32
  ds_read_b64_tr_b16 v[84:85], v41 offset:0
  ds_read_b64_tr_b16 v[86:87], v41 offset:2048
  ds_read_b64_tr_b16 v[88:89], v42 offset:0
  ds_read_b64_tr_b16 v[90:91], v42 offset:2048
  ds_read_b64_tr_b16 v[92:93], v43 offset:0
  ds_read_b64_tr_b16 v[94:95], v43 offset:2048
  ds_read_b64_tr_b16 v[96:97], v44 offset:0
  ds_read_b64_tr_b16 v[98:99], v44 offset:2048
  ds_read_b64_tr_b16 v[100:101], v41 offset:4096
  ds_read_b64_tr_b16 v[102:103], v41 offset:6144
  ds_read_b64_tr_b16 v[104:105], v42 offset:4096
  ds_read_b64_tr_b16 v[106:107], v42 offset:6144
  ds_read_b64_tr_b16 v[108:109], v43 offset:4096
  ds_read_b64_tr_b16 v[110:111], v43 offset:6144
  ds_read_b64_tr_b16 v[112:113], v44 offset:4096
  ds_read_b64_tr_b16 v[114:115], v44 offset:6144
  s_waitcnt lgkmcnt(0)
  s_add_u32 s50, s48, 294912
  s_add_u32 s51, s49, 0
  s_mov_b32 m0, s51
  s_nop 0
  buffer_load_dwordx4 v40, s[36:39], s50 offen nt lds
  s_add_u32 s50, s48, 319488
  s_add_u32 s51, s49, 1024
  s_mov_b32 m0, s51
  s_nop 0
  buffer_load_dwordx4 v40, s[36:39], s50 offen nt lds
  s_add_u32 s50, s48, 344064
  s_add_u32 s51, s49, 2048
  s_mov_b32 m0, s51
  s_nop 0
  buffer_load_dwordx4 v40, s[36:39], s50 offen nt lds
  s_add_u32 s50, s48, 368640
  s_add_u32 s51, s49, 3072
  s_mov_b32 m0, s51
  s_nop 0
  buffer_load_dwordx4 v40, s[36:39], s50 offen nt lds
  s_add_u32 s50, s48, 294912
  s_add_u32 s51, s49, 4096
  s_mov_b32 m0, s51
  s_nop 0
  buffer_load_dwordx4 v40, s[44:47], s50 offen nt lds
  s_add_u32 s50, s48, 319488
  s_add_u32 s51, s49, 5120
  s_mov_b32 m0, s51
  s_nop 0
  buffer_load_dwordx4 v40, s[44:47], s50 offen nt lds
  s_add_u32 s50, s48, 344064
  s_add_u32 s51, s49, 6144
  s_mov_b32 m0, s51
  s_nop 0
  buffer_load_dwordx4 v40, s[44:47], s50 offen nt lds
  s_add_u32 s50, s48, 368640
  s_add_u32 s51, s49, 7168
  s_mov_b32 m0, s51
  s_nop 0
  buffer_load_dwordx4 v40, s[44:47], s50 offen nt lds
  v_mfma_f32_16x16x32_bf16 v[48:51], v[80:83], v[84:87], v[48:51]
  v_mfma_f32_16x16x32_bf16 v[52:55], v[80:83], v[88:91], v[52:55]
  v_mfma_f32_16x16x32_bf16 v[56:59], v[80:83], v[92:95], v[56:59]
  v_mfma_f32_16x16x32_bf16 v[60:63], v[80:83], v[96:99], v[60:63]
  v_mfma_f32_16x16x32_bf16 v[64:67], v[80:83], v[100:103], v[64:67]
  v_mfma_f32_16x16x32_bf16 v[68:71], v[80:83], v[104:107], v[68:71]
  v_mfma_f32_16x16x32_bf16 v[72:75], v[80:83], v[108:111], v[72:75]
  v_mfma_f32_16x16x32_bf16 v[76:79], v[80:83], v[112:115], v[76:79]
  s_waitcnt vmcnt(16)
  ds_read_b64 v[80:81], v45 offset:64
  ds_read_b64 v[82:83], v45 offset:96
  ds_read_b64_tr_b16 v[84:85], v41 offset:8192
  ds_read_b64_tr_b16 v[86:87], v41 offset:10240
  ds_read_b64_tr_b16 v[88:89], v42 offset:8192
  ds_read_b64_tr_b16 v[90:91], v42 offset:10240
  ds_read_b64_tr_b16 v[92:93], v43 offset:8192
  ds_read_b64_tr_b16 v[94:95], v43 offset:10240
  ds_read_b64_tr_b16 v[96:97], v44 offset:8192
  ds_read_b64_tr_b16 v[98:99], v44 offset:10240
  ds_read_b64_tr_b16 v[100:101], v41 offset:12288
  ds_read_b64_tr_b16 v[102:103], v41 offset:14336
  ds_read_b64_tr_b16 v[104:105], v42 offset:12288
  ds_read_b64_tr_b16 v[106:107], v42 offset:14336
  ds_read_b64_tr_b16 v[108:109], v43 offset:12288
  ds_read_b64_tr_b16 v[110:111], v43 offset:14336
  ds_read_b64_tr_b16 v[112:113], v44 offset:12288
  ds_read_b64_tr_b16 v[114:115], v44 offset:14336
  s_waitcnt lgkmcnt(0)
  s_add_u32 s50, s48, 393216
  s_add_u32 s51, s49, 8192
  s_mov_b32 m0, s51
  s_nop 0
  buffer_load_dwordx4 v40, s[36:39], s50 offen nt lds
  s_add_u32 s50, s48, 417792
  s_add_u32 s51, s49, 9216
  s_mov_b32 m0, s51
  s_nop 0
  buffer_load_dwordx4 v40, s[36:39], s50 offen nt lds
  s_add_u32 s50, s48, 442368
  s_add_u32 s51, s49, 10240
  s_mov_b32 m0, s51
  s_nop 0
  buffer_load_dwordx4 v40, s[36:39], s50 offen nt lds
  s_add_u32 s50, s48, 466944
  s_add_u32 s51, s49, 11264
  s_mov_b32 m0, s51
  s_nop 0
  buffer_load_dwordx4 v40, s[36:39], s50 offen nt lds
  s_add_u32 s50, s48, 393216
  s_add_u32 s51, s49, 12288
  s_mov_b32 m0, s51
  s_nop 0
  buffer_load_dwordx4 v40, s[44:47], s50 offen nt lds
  s_add_u32 s50, s48, 417792
  s_add_u32 s51, s49, 13312
  s_mov_b32 m0, s51
  s_nop 0
  buffer_load_dwordx4 v40, s[44:47], s50 offen nt lds
  s_add_u32 s50, s48, 442368
  s_add_u32 s51, s49, 14336
  s_mov_b32 m0, s51
  s_nop 0
  buffer_load_dwordx4 v40, s[44:47], s50 offen nt lds
  s_add_u32 s50, s48, 466944
  s_add_u32 s51, s49, 15360
  s_mov_b32 m0, s51
  s_nop 0
  buffer_load_dwordx4 v40, s[44:47], s50 offen nt lds
  v_mfma_f32_16x16x32_bf16 v[48:51], v[80:83], v[84:87], v[48:51]
  v_mfma_f32_16x16x32_bf16 v[52:55], v[80:83], v[88:91], v[52:55]
  v_mfma_f32_16x16x32_bf16 v[56:59], v[80:83], v[92:95], v[56:59]
  v_mfma_f32_16x16x32_bf16 v[60:63], v[80:83], v[96:99], v[60:63]
  v_mfma_f32_16x16x32_bf16 v[64:67], v[80:83], v[100:103], v[64:67]
  v_mfma_f32_16x16x32_bf16 v[68:71], v[80:83], v[104:107], v[68:71]
  v_mfma_f32_16x16x32_bf16 v[72:75], v[80:83], v[108:111], v[72:75]
  v_mfma_f32_16x16x32_bf16 v[76:79], v[80:83], v[112:115], v[76:79]
  s_waitcnt vmcnt(16)
  ds_read_b64 v[80:81], v45 offset:128
  ds_read_b64 v[82:83], v45 offset:160
  ds_read_b64_tr_b16 v[84:85], v41 offset:16384
  ds_read_b64_tr_b16 v[86:87], v41 offset:18432
  ds_read_b64_tr_b16 v[88:89], v42 offset:16384
  ds_read_b64_tr_b16 v[90:91], v42 offset:18432
  ds_read_b64_tr_b16 v[92:93], v43 offset:16384
  ds_read_b64_tr_b16 v[94:95], v43 offset:18432
  ds_read_b64_tr_b16 v[96:97], v44 offset:16384
  ds_read_b64_tr_b16 v[98:99], v44 offset:18432
  ds_read_b64_tr_b16 v[100:101], v41 offset:20480
  ds_read_b64_tr_b16 v[102:103], v41 offset:22528
  ds_read_b64_tr_b16 v[104:105], v42 offset:20480
  ds_read_b64_tr_b16 v[106:107], v42 offset:22528
  ds_read_b64_tr_b16 v[108:109], v43 offset:20480
  ds_read_b64_tr_b16 v[110:111], v43 offset:22528
  ds_read_b64_tr_b16 v[112:113], v44 offset:20480
  ds_read_b64_tr_b16 v[114:115], v44 offset:22528
  s_waitcnt lgkmcnt(0)
  v_mfma_f32_16x16x32_bf16 v[48:51], v[80:83], v[84:87], v[48:51]
  v_mfma_f32_16x16x32_bf16 v[52:55], v[80:83], v[88:91], v[52:55]
  v_mfma_f32_16x16x32_bf16 v[56:59], v[80:83], v[92:95], v[56:59]
  v_mfma_f32_16x16x32_bf16 v[60:63], v[80:83], v[96:99], v[60:63]
  v_mfma_f32_16x16x32_bf16 v[64:67], v[80:83], v[100:103], v[64:67]
  v_mfma_f32_16x16x32_bf16 v[68:71], v[80:83], v[104:107], v[68:71]
  v_mfma_f32_16x16x32_bf16 v[72:75], v[80:83], v[108:111], v[72:75]
  v_mfma_f32_16x16x32_bf16 v[76:79], v[80:83], v[112:115], v[76:79]
  s_waitcnt vmcnt(8)
  ds_read_b64 v[80:81], v45 offset:192
  ds_read_b64 v[82:83], v45 offset:224
  ds_read_b64_tr_b16 v[84:85], v41 offset:0
  ds_read_b64_tr_b16 v[86:87], v41 offset:2048
  ds_read_b64_tr_b16 v[88:89], v42 offset:0
  ds_read_b64_tr_b16 v[90:91], v42 offset:2048
  ds_read_b64_tr_b16 v[92:93], v43 offset:0
  ds_read_b64_tr_b16 v[94:95], v43 offset:2048
  ds_read_b64_tr_b16 v[96:97], v44 offset:0
  ds_read_b64_tr_b16 v[98:99], v44 offset:2048
  ds_read_b64_tr_b16 v[100:101], v41 offset:4096
  ds_read_b64_tr_b16 v[102:103], v41 offset:6144
  ds_read_b64_tr_b16 v[104:105], v42 offset:4096
  ds_read_b64_tr_b16 v[106:107], v42 offset:6144
  ds_read_b64_tr_b16 v[108:109], v43 offset:4096
  ds_read_b64_tr_b16 v[110:111], v43 offset:6144
  ds_read_b64_tr_b16 v[112:113], v44 offset:4096
  ds_read_b64_tr_b16 v[114:115], v44 offset:6144
  s_waitcnt lgkmcnt(0)
  v_mfma_f32_16x16x32_bf16 v[48:51], v[80:83], v[84:87], v[48:51]
  v_mfma_f32_16x16x32_bf16 v[52:55], v[80:83], v[88:91], v[52:55]
  v_mfma_f32_16x16x32_bf16 v[56:59], v[80:83], v[92:95], v[56:59]
  v_mfma_f32_16x16x32_bf16 v[60:63], v[80:83], v[96:99], v[60:63]
  v_mfma_f32_16x16x32_bf16 v[64:67], v[80:83], v[100:103], v[64:67]
  v_mfma_f32_16x16x32_bf16 v[68:71], v[80:83], v[104:107], v[68:71]
  v_mfma_f32_16x16x32_bf16 v[72:75], v[80:83], v[108:111], v[72:75]
  v_mfma_f32_16x16x32_bf16 v[76:79], v[80:83], v[112:115], v[76:79]
  s_waitcnt vmcnt(0)
  ds_read_b64 v[80:81], v45 offset:256
  ds_read_b64 v[82:83], v45 offset:288
  ds_read_b64_tr_b16 v[84:85], v41 offset:8192
  ds_read_b64_tr_b16 v[86:87], v41 offset:10240
  ds_read_b64_tr_b16 v[88:89], v42 offset:8192
  ds_read_b64_tr_b16 v[90:91], v42 offset:10240
  ds_read_b64_tr_b16 v[92:93], v43 offset:8192
  ds_read_b64_tr_b16 v[94:95], v43 offset:10240
  ds_read_b64_tr_b16 v[96:97], v44 offset:8192
  ds_read_b64_tr_b16 v[98:99], v44 offset:10240
  ds_read_b64_tr_b16 v[100:101], v41 offset:12288
  ds_read_b64_tr_b16 v[102:103], v41 offset:14336
  ds_read_b64_tr_b16 v[104:105], v42 offset:12288
  ds_read_b64_tr_b16 v[106:107], v42 offset:14336
  ds_read_b64_tr_b16 v[108:109], v43 offset:12288
  ds_read_b64_tr_b16 v[110:111], v43 offset:14336
  ds_read_b64_tr_b16 v[112:113], v44 offset:12288
  ds_read_b64_tr_b16 v[114:115], v44 offset:14336
  s_waitcnt lgkmcnt(0)
  v_mfma_f32_16x16x32_bf16 v[48:51], v[80:83], v[84:87], v[48:51]
  v_mfma_f32_16x16x32_bf16 v[52:55], v[80:83], v[88:91], v[52:55]
  v_mfma_f32_16x16x32_bf16 v[56:59], v[80:83], v[92:95], v[56:59]
  v_mfma_f32_16x16x32_bf16 v[60:63], v[80:83], v[96:99], v[60:63]
  v_mfma_f32_16x16x32_bf16 v[64:67], v[80:83], v[100:103], v[64:67]
  v_mfma_f32_16x16x32_bf16 v[68:71], v[80:83], v[104:107], v[68:71]
  v_mfma_f32_16x16x32_bf16 v[72:75], v[80:83], v[108:111], v[72:75]
  v_mfma_f32_16x16x32_bf16 v[76:79], v[80:83], v[112:115], v[76:79]
  v_lshrrev_b32 v46, 4, v1
  v_and_b32 v3, 15, v1
  v_lshlrev_b32 v3, 2, v3
  v_lshl_add_u32 v3, v46, 8, v3
  s_lshl_b32 s40, s31, 11
  s_add_u32 s40, s40, 11264
  v_add_u32 v47, s40, v3
  v_mov_b32 v5, v48
  v_cmp_eq_u32 vcc, 1, v46
  s_nop 1
  v_cndmask_b32 v5, v5, v49, vcc
  v_cmp_eq_u32 vcc, 2, v46
  s_nop 1
  v_cndmask_b32 v5, v5, v50, vcc
  v_cmp_eq_u32 vcc, 3, v46
  s_nop 1
  v_cndmask_b32 v5, v5, v51, vcc
  ds_write_b32 v47, v5 offset:0
  v_mov_b32 v5, v52
  v_cmp_eq_u32 vcc, 1, v46
  s_nop 1
  v_cndmask_b32 v5, v5, v53, vcc
  v_cmp_eq_u32 vcc, 2, v46
  s_nop 1
  v_cndmask_b32 v5, v5, v54, vcc
  v_cmp_eq_u32 vcc, 3, v46
  s_nop 1
  v_cndmask_b32 v5, v5, v55, vcc
  ds_write_b32 v47, v5 offset:64
  v_mov_b32 v5, v56
  v_cmp_eq_u32 vcc, 1, v46
  s_nop 1
  v_cndmask_b32 v5, v5, v57, vcc
  v_cmp_eq_u32 vcc, 2, v46
  s_nop 1
  v_cndmask_b32 v5, v5, v58, vcc
  v_cmp_eq_u32 vcc, 3, v46
  s_nop 1
  v_cndmask_b32 v5, v5, v59, vcc
  ds_write_b32 v47, v5 offset:128
  v_mov_b32 v5, v60
  v_cmp_eq_u32 vcc, 1, v46
  s_nop 1
  v_cndmask_b32 v5, v5, v61, vcc
  v_cmp_eq_u32 vcc, 2, v46
  s_nop 1
  v_cndmask_b32 v5, v5, v62, vcc
  v_cmp_eq_u32 vcc, 3, v46
  s_nop 1
  v_cndmask_b32 v5, v5, v63, vcc
  ds_write_b32 v47, v5 offset:192
  v_mov_b32 v5, v64
  v_cmp_eq_u32 vcc, 1, v46
  s_nop 1
  v_cndmask_b32 v5, v5, v65, vcc
  v_cmp_eq_u32 vcc, 2, v46
  s_nop 1
  v_cndmask_b32 v5, v5, v66, vcc
  v_cmp_eq_u32 vcc, 3, v46
  s_nop 1
  v_cndmask_b32 v5, v5, v67, vcc
  ds_write_b32 v47, v5 offset:1024
  v_mov_b32 v5, v68
  v_cmp_eq_u32 vcc, 1, v46
  s_nop 1
  v_cndmask_b32 v5, v5, v69, vcc
  v_cmp_eq_u32 vcc, 2, v46
  s_nop 1
  v_cndmask_b32 v5, v5, v70, vcc
  v_cmp_eq_u32 vcc, 3, v46
  s_nop 1
  v_cndmask_b32 v5, v5, v71, vcc
  ds_write_b32 v47, v5 offset:1088
  v_mov_b32 v5, v72
  v_cmp_eq_u32 vcc, 1, v46
  s_nop 1
  v_cndmask_b32 v5, v5, v73, vcc
  v_cmp_eq_u32 vcc, 2, v46
  s_nop 1
  v_cndmask_b32 v5, v5, v74, vcc
  v_cmp_eq_u32 vcc, 3, v46
  s_nop 1
  v_cndmask_b32 v5, v5, v75, vcc
  ds_write_b32 v47, v5 offset:1152
  v_mov_b32 v5, v76
  v_cmp_eq_u32 vcc, 1, v46
  s_nop 1
  v_cndmask_b32 v5, v5, v77, vcc
  v_cmp_eq_u32 vcc, 2, v46
  s_nop 1
  v_cndmask_b32 v5, v5, v78, vcc
  v_cmp_eq_u32 vcc, 3, v46
  s_nop 1
  v_cndmask_b32 v5, v5, v79, vcc
  ds_write_b32 v47, v5 offset:1216
  s_waitcnt lgkmcnt(0)
  s_add_u32 s58, s58, 4
  v_mov_b32 v2, 5376
  v_mov_b32 v3, 1
  s_mov_b64 exec, 1
  ds_add_u32 v2, v3
  s_mov_b64 exec, -1
  s_mov_b32 s79, 524288
L_ab_25:
  ds_read_b32 v4, v2
  s_waitcnt lgkmcnt(0)
  v_readfirstlane_b32 s78, v4
  s_nop 0
  s_cmp_ge_u32 s78, s58
  s_cbranch_scc1 L_abx_26
  s_sleep 1
  s_sub_u32 s79, s79, 1
  s_cbranch_scc0 L_ab_25
  v_mov_b32 v2, 4
  v_mov_b32 v3, 1
  global_store_dword v2, v3, s[24:25]
L_abx_26:
  s_lshl_b32 s40, s31, 8
  s_add_u32 s40, s40, 11264
  v_lshl_add_u32 v5, v1, 2, s40
  ds_read_b32 v10, v5 offset:0
  ds_read_b32 v14, v5 offset:1024
  ds_read_b32 v11, v5 offset:2048
  ds_read_b32 v15, v5 offset:3072
  ds_read_b32 v12, v5 offset:4096
  ds_read_b32 v16, v5 offset:5120
  ds_read_b32 v13, v5 offset:6144
  ds_read_b32 v17, v5 offset:7168
  s_waitcnt lgkmcnt(0)
  v_add_f32 v10, v10, v11
  v_add_f32 v12, v12, v13
  v_add_f32 v10, v10, v12
  v_add_f32 v14, v14, v15
  v_add_f32 v16, v16, v17
  v_add_f32 v14, v14, v16
  v_cvt_pk_bf16_f32 v10, v10, v10
  v_and_b32 v10, 0xffff0000, v10
  v_cvt_pk_bf16_f32 v14, v14, v14
  v_and_b32 v14, 0xffff0000, v14
  v_mul_f32 v11, v10, v10
  v_mul_f32 v11, 0x3d372713, v11
  v_fma_f32 v11, v11, v10, v10
  v_mul_f32 v11, 0xc0135761, v11
  v_exp_f32 v11, v11
  s_nop 0
  v_add_f32 v11, 1.0, v11
  v_rcp_f32 v11, v11
  s_nop 0
  v_mul_f32 v11, v10, v11
  v_cvt_pk_bf16_f32 v11, v11, v11
  v_and_b32 v11, 0xffff0000, v11
  v_mul_f32 v11, v11, v14
  v_cvt_pk_bf16_f32 v11, v11, v11
  v_and_b32 v11, 0xffff0000, v11
  s_nop 1
  v_mov_b32_dpp v12, v11 quad_perm:[1,0,3,2] row_mask:0xf bank_mask:0xf
  v_lshrrev_b32 v13, 16, v11
  v_or_b32 v13, v13, v12
  s_nop 1
  v_mov_b32_dpp v14, v13 quad_perm:[2,3,0,1] row_mask:0xf bank_mask:0xf
  v_mov_b32 v20, v13
  v_mov_b32 v21, s60
  v_mov_b32 v22, v14
  v_mov_b32 v23, s61
  s_lshl_b32 s40, s28, 10
  s_lshl_b32 s41, s31, 8
  s_add_u32 s40, s40, s41
  s_add_u32 s40, s40, 1048576
  v_lshl_add_u32 v6, v1, 2, s40
  s_mov_b32 exec_lo, 0x11111111
  s_mov_b32 exec_hi, 0x11111111
  global_store_dwordx4 v6, v[20:23], s[26:27] sc1
  s_mov_b64 exec, -1
  s_branch A_tail
L_end:
  s_endpgm
.section .rodata,"a"
.p2align 6
.amdhsa_kernel recurrent_scan__mha_block_cached__geglu_ffn__decode_kernel
  .amdhsa_next_free_vgpr 256
  .amdhsa_next_free_sgpr 96
  .amdhsa_accum_offset 256
  .amdhsa_group_segment_fixed_size 0
  .amdhsa_kernarg_size 96
  .amdhsa_user_sgpr_count 2
  .amdhsa_user_sgpr_kernarg_segment_ptr 1
  .amdhsa_system_sgpr_workgroup_id_x 1
  .amdhsa_float_denorm_mode_32 3
.end_amdhsa_kernel
```
